```python
import torch

def _softmax(x, axis=-1):
    return torch.softmax(x, dim=axis)
def _gelu(x):
    return torch.nn.functional.gelu(x, approximate="tanh")
def _silu(x):
    return torch.nn.functional.silu(x)
def _sigmoid(x):
    return torch.sigmoid(x)
def _layernorm(x, axis=-1, eps=1e-5):
    m = x.mean(dim=axis, keepdim=True)
    v = x.var(dim=axis, keepdim=True, unbiased=False)
    return (x - m) / torch.sqrt(v + eps)
def _scatter_add(tgt, idx, src, axis=0):
    return tgt.clone().index_add_(axis, idx, src)
def _segment_sum(src, seg, n):
    out = torch.zeros((n,) + src.shape[1:], dtype=src.dtype)
    return out.index_add_(0, seg, src)
def _pad(x, pw):
    flat = tuple(v for pair in reversed(pw) for v in pair)
    return torch.nn.functional.pad(x, flat)

kernel_name = 'standalone__spectral_conv_sgc__graph'

def setup_inputs():

    _w = (lambda a: (lambda t: t.to(torch.bfloat16) if t.is_floating_point() else t)(torch.as_tensor(a)))
    N, deg, D = 50000, 16, 64
    E = N * deg
    rs = (lambda lo, hi, *s: torch.randint(lo, hi, s))(0, N, E).to(torch.int64)
    rd = (lambda lo, hi, *s: torch.randint(lo, hi, s))(0, N, E).to(torch.int64)
    loop = torch.arange(N).to(torch.int64)
    src = torch.cat([rs, loop])
    dst = torch.cat([rd, loop])
    deg_cnt = torch.bincount(dst, minlength=N).to(float)
    dis = 1.0 / (lambda _x: torch.sqrt(torch.as_tensor(_x)))(deg_cnt)
    return {
        "x": _w((lambda *s: torch.randn(*s, dtype=torch.bfloat16) * 0.05)(N, D)),
        "src": _w(src),
        "dst": _w(dst),
        "norm": _w((dis[src] * dis[dst]).to(float)),
        "w": _w((lambda *s: torch.randn(*s, dtype=torch.bfloat16) * 0.05)(D, D)),
    }

def reference(x, src, dst, norm, w):
    N = x.shape[0]
    h = x
    for _ in range(2):
        msg = h[src] * norm[:, None]
        h = _segment_sum(msg, dst, N)
    return h @ w
```

```asm
; @launch grid=(256,1,1) block=(1024,1,1) lds=118144
.amdgcn_target "amdgcn-amd-amdhsa--gfx950"
.text
.globl standalone__spectral_conv_sgc__graph_kernel
.p2align 8
.type standalone__spectral_conv_sgc__graph_kernel,@function
standalone__spectral_conv_sgc__graph_kernel:
    s_getpc_b64 s[6:7]
CPF_PC:
    v_cmp_gt_u32 vcc, (SLOWW-CPF_PC+127)/128, v0
    v_lshlrev_b32 v2, 7, v0
    s_load_dwordx2 s[24:25], s[0:1], 16
    s_mov_b64 exec, vcc
    s_mov_b32 s8, vcc_lo
    s_cbranch_execz CPF_D
    global_load_dword v126, v2, s[6:7] offset:124
CPF_D:
    s_load_dwordx2 s[20:21], s[0:1], 8
    s_load_dwordx2 s[28:29], s[0:1], 24
    s_load_dwordx2 s[10:11], s[0:1], 56
    s_mov_b64 exec, -1
    s_cmp_ge_u32 s2, 256
    s_cbranch_scc1 END
    v_lshrrev_b32 v3, 6, v0
    v_and_b32 v2, 63, v0
    s_mov_b32 s23, 0x20000
    s_mov_b32 s22, 3400000
    v_lshlrev_b32 v4, 18, v3
    s_mov_b64 s[26:27], s[22:23]
    v_lshl_or_b32 v4, v2, 4, v4
    s_lshr_b32 s30, s22, 1
    s_mov_b32 s31, s23
    v_bfe_i32 v5, v0, 6, 1
    s_lshl_b32 s68, s2, 10
    v_and_b32 v5, 0x6000, v5
    v_cmp_gt_u32 vcc, 13, v3
    v_xad_u32 v4, v5, s68, v4
    v_lshrrev_b32 v5, 1, v4
    v_mov_b32 v125, 8519680
    s_cmp_eq_u32 s8, 0
    s_waitcnt lgkmcnt(0)
    s_cbranch_scc1 A_NOZ
    global_load_dword v125, v125, s[10:11] sc1
A_NOZ:
    s_cbranch_vccz A_NOLD0
    buffer_load_dwordx4 v[12:15], v4, s[24:27], 0 offen
A_NOLD0:
    s_barrier
    s_cbranch_vccz A_NOLD
    buffer_load_dwordx4 v[16:19], v4, s[20:23], 0 offen
    buffer_load_dwordx2 v[20:21], v5, s[28:31], 0 offen
A_NOLD:
    s_load_dwordx8 s[12:19], s[0:1], 32
    s_load_dwordx2 s[4:5], s[0:1], 0
    v_readfirstlane_b32 s3, v3
    v_lshlrev_b32 v9, 2, v0
    v_mov_b32 v6, 0
    ds_write_b32 v9, v6 offset:33792
    v_mov_b32 v24, -1
    v_mov_b32 v25, -1
    v_mov_b32 v26, -1
    v_mov_b32 v27, -1
    v_lshlrev_b32 v7, 4, v0
    ds_write_b128 v7, v[24:27]
    ds_write_b128 v7, v[24:27] offset:16384
    v_lshrrev_b32 v8, 2, v4
    v_cmp_gt_u32 s[72:73], s22, v4
    v_subrev_u32 v8, 800000, v8
    v_mov_b32 v1, 1
    v_and_b32 v10, 7, v0
    s_mov_b64 s[32:33], s[10:11]
    s_mov_b32 s34, 25395200
    s_mov_b32 s35, s23
    s_cmp_lg_u32 s3, 15
    s_cbranch_scc1 A_BAR
    ds_write_b128 v7, v[24:27] offset:17408
    v_and_b32 v5, 124, v9
    v_mov_b32 v7, 0xffff
    ds_write_b32 v5, v7 offset:37888
A_BAR:
    s_lshr_b32 s76, s2, 7
    s_add_u32 s77, s76, s2
    s_and_b32 s77, s77, 3
    s_lshl_b32 s77, s77, 6
    s_lshl1_add_u32 s77, s76, s77
    s_bfe_u32 s76, s2, 0x40003
    s_lshl2_add_u32 s77, s76, s77
    s_bfe_u32 s76, s2, 0x10002
    s_add_u32 s65, s77, s76
    s_cmp_lt_u32 s3, 4
    s_cbranch_scc1 A_PRD
    s_setprio 1
    s_cmp_lt_u32 s3, 8
    s_cbranch_scc1 A_PRD
    s_setprio 2
    s_cmp_lt_u32 s3, 12
    s_cbranch_scc1 A_PRD
    s_setprio 3
A_PRD:
    s_waitcnt lgkmcnt(0)
    s_barrier
    s_cmp_lt_u32 s3, 12
    s_cbranch_scc1 A_SETUP
    v_bfe_u32 v2, v0, 4, 4
    s_lshl_b32 s76, s65, 4
    v_add_u32 v2, s76, v2
    v_mul_u32_u24 v3, 50006, v2
    v_lshrrev_b32 v3, 12, v3
    v_sub_u32 v4, v0, v3
    v_and_b32 v4, 15, v4
    v_add_u32 v115, v3, v4
    v_add_u32 v4, 800000, v115
    v_lshlrev_b32 v5, 2, v4
    v_lshlrev_b32 v4, 1, v4
    buffer_load_dword v112, v5, s[24:27], 0 offen
    buffer_load_dword v113, v5, s[20:23], 0 offen
    buffer_load_ushort v114, v4, s[28:31], 0 offen
    v_mul_u32_u24 v4, 5368, v115
    v_lshrrev_b32 v4, 16, v4
    v_cmp_eq_u32 s[66:67], v4, v2
    v_cmp_gt_u32 vcc, 50000, v115
    s_and_b64 s[66:67], s[66:67], vcc
    s_cmp_eq_u32 s3, 12
    s_cbranch_scc1 A_SETUP
    s_mov_b64 s[44:45], s[12:13]
    s_mov_b32 s46, 8192
    s_mov_b32 s47, s23
    v_subrev_u32 v2, 832, v0
    v_lshlrev_b32 v2, 4, v2
    buffer_load_dwordx4 v[100:103], v2, s[44:47], 0 offen
    buffer_load_dwordx4 v[104:107], v2, s[44:47], 0 offen offset:3072
    v_add_u32 v3, 6144, v2
    buffer_load_dwordx4 v[108:111], v3, s[44:47], 0 offen
A_SETUP:
    s_lshr_b32 s76, s3, 1
    s_add_u32 s76, s76, s2
    s_and_b32 s76, s76, 7
    s_lshl_b32 s74, s2, 15
    s_lshl_b32 s77, s76, 12
    s_add_u32 s74, s74, s77
    s_lshl_b32 s77, s76, 2
    v_mov_b32 v49, s77
    s_and_b32 s75, s3, 1
    s_lshl_b32 s75, s75, 1
    v_bfe_u32 v2, v0, 3, 3
    v_lshlrev_b32 v48, 4, v10
    v_cmp_lt_u32 vcc, 3, v10
    v_mul_u32_u24 v3, 528, v2
    s_and_b32 s70, s3, 1
    s_add_u32 s77, s76, s70
    s_and_b32 s77, s77, 3
    s_lshl_b32 s77, s77, 6
    s_lshl1_add_u32 s77, s70, s77
    s_lshr_b32 s76, s76, 2
    s_add_u32 s76, s76, s77
    v_add_u32 v3, v3, v48
    s_add_u32 s77, s76, 0
    s_mul_i32 s77, s77, 132
    v_add_u32 v40, s77, v3
    v_lshl_add_u32 v46, s75, 3, v2
    v_lshlrev_b32 v44, v46, v1
    v_add_u32 v42, -1, v44
    v_cndmask_b32 v44, 0, v44, vcc
    s_add_u32 s75, s75, 1
    s_add_u32 s77, s76, 32
    s_mul_i32 s77, s77, 132
    v_add_u32 v41, s77, v3
    v_lshl_add_u32 v47, s75, 3, v2
    v_lshlrev_b32 v45, v47, v1
    v_add_u32 v43, -1, v45
    v_cndmask_b32 v45, 0, v45, vcc
    s_add_u32 s75, s75, 1
    v_and_b32 v50, 6, v10
    s_mov_b32 s64, 0xffffff
    s_cmp_lt_u32 s3, 12
    s_cbranch_scc1 A_EDGES
    s_cmp_eq_u32 s3, 12
    s_cbranch_scc1 A_EDGES12
    s_cmp_eq_u32 s3, 15
    s_cbranch_scc1 A_MASKS
    s_cmp_eq_u32 s3, 14
    s_cbranch_scc1 A_HDR
    s_branch A_OUT
A_MASKS:
    v_bfe_u32 v2, v0, 4, 1
    v_bfe_u32 v3, v0, 5, 1
    v_add_u32 v3, v3, v2
    v_lshlrev_b32 v3, 6, v3
    v_lshl_add_u32 v3, v2, 1, v3
    v_and_b32 v2, 15, v0
    v_lshl_add_u32 v3, v2, 2, v3
    v_lshlrev_b32 v12, 2, v3
    v_xor_b32 v13, 512, v12
    v_lshlrev_b32 v7, 2, v10
A_MPOLL:
    ds_read_b32 v2, v6 offset:34820
    s_waitcnt lgkmcnt(0)
    v_cmp_gt_u32 vcc, 13, v2
    s_cbranch_vccnz A_MPOLL
    ds_read_b32 v16, v12 offset:33792
    ds_read_b32 v17, v13 offset:33792
    ds_read_b32 v18, v12 offset:33796
    ds_read_b32 v19, v13 offset:33796
    s_waitcnt lgkmcnt(3)
    v_cmp_lt_u32 s[52:53], 12, v16
    s_waitcnt lgkmcnt(2)
    v_cmp_lt_u32 s[54:55], 12, v17
    s_waitcnt lgkmcnt(1)
    v_cmp_lt_u32 s[56:57], 12, v18
    s_waitcnt lgkmcnt(0)
    v_cmp_lt_u32 s[58:59], 12, v19
    s_nop 1
    v_writelane_b32 v2, s52, 0
    v_writelane_b32 v2, s53, 1
    v_writelane_b32 v2, s54, 2
    v_writelane_b32 v2, s55, 3
    v_writelane_b32 v2, s56, 4
    v_writelane_b32 v2, s57, 5
    v_writelane_b32 v2, s58, 6
    v_writelane_b32 v2, s59, 7
    s_mov_b64 exec, 0xff
    v_bcnt_u32_b32 v3, v2, 0
    v_add_u32 v4, 1, v2
    v_bfe_i32 v3, v3, 0, 1
    v_bfi_b32 v4, v2, 0, v4
    v_and_or_b32 v2, v4, v3, v2
    ds_write_b32 v7, v2 offset:38032
    s_branch A_OUT
A_HDR:
    v_and_b32 v3, 15, v0
    v_lshlrev_b32 v51, 3, v3
    v_bfe_u32 v52, v0, 4, 2
    v_and_b32 v53, 1, v0
    v_lshl_add_u32 v53, v52, 1, v53
    v_lshlrev_b32 v53, 2, v53
    v_lshl_or_b32 v52, v52, 15, v51
    v_bfe_u32 v54, v0, 2, 1
    v_lshlrev_b32 v54, 1, v54
    s_lshl_b32 s75, s2, 7
    s_add_u32 s75, s75, 8388608
    v_cmp_le_u32 vcc, 14, v3
    s_setprio 3
    s_barrier
    ds_read_u16 v26, v54 offset:38016
    ds_read_b64 v[24:25], v51 offset:37888
    ds_read_b32 v22, v6 offset:34816
    ds_read_b32 v23, v53 offset:38032
    s_waitcnt lgkmcnt(0)
    v_or_b32 v22, 0xf000, v22
    v_cndmask_b32 v24, v24, v23, vcc
    v_cndmask_b32 v25, v25, v22, vcc
    v_lshl_or_b32 v25, v26, 16, v25
    buffer_store_dwordx2 v[24:25], v52, s[32:35], s75 offen sc1
    ds_read_u16 v120, v50 offset:38016
    s_branch A_O1
A_EDGES12:
    s_waitcnt vmcnt(5)
    s_branch A_EDGES2
A_EDGES:
    s_cmp_lg_u32 s3, 0
    s_waitcnt vmcnt(2)
    s_cbranch_scc1 A_EDGES2
    v_add_u32 v4, 0x01010101, v125
    v_add_u32 v5, 0x01010101, v125
    ds_write_b64 v6, v[4:5] offset:38016
A_EDGES2:
    s_mov_b64 exec, s[72:73]
    v_mul_u32_u24 v24, 5368, v12
    v_sub_u32 v2, v12, v8
    v_lshrrev_b32 v28, 20, v24
    v_cmp_ne_u32 s[52:53], 0, v2
    v_lshlrev_b32 v36, 2, v28
    v_mul_u32_u24 v25, 5368, v13
    v_sub_u32 v2, v13, v8
    v_lshrrev_b32 v29, 20, v25
    v_cmp_ne_u32 s[54:55], 1, v2
    v_lshlrev_b32 v37, 2, v29
    v_mul_u32_u24 v26, 5368, v14
    v_sub_u32 v2, v14, v8
    v_lshrrev_b32 v30, 20, v26
    v_cmp_ne_u32 s[56:57], 2, v2
    v_lshlrev_b32 v38, 2, v30
    v_mul_u32_u24 v27, 5368, v15
    v_sub_u32 v2, v15, v8
    v_lshrrev_b32 v31, 20, v27
    v_cmp_ne_u32 s[58:59], 3, v2
    v_lshlrev_b32 v39, 2, v31
    s_mov_b64 exec, s[52:53]
    ds_add_rtn_u32 v32, v36, v1 offset:33792
    s_mov_b64 exec, s[54:55]
    ds_add_rtn_u32 v33, v37, v1 offset:33792
    s_mov_b64 exec, s[56:57]
    ds_add_rtn_u32 v34, v38, v1 offset:33792
    s_mov_b64 exec, s[58:59]
    ds_add_rtn_u32 v35, v39, v1 offset:33792
    s_mov_b64 exec, 1
    ds_add_u32 v6, v1 offset:34820
    s_mov_b64 exec, s[72:73]
    v_lshrrev_b32 v24, 12, v24
    v_mul_u32_u24 v28, 132, v28
    v_bfi_b32 v24, 15, v12, v24
    v_lshrrev_b32 v25, 12, v25
    v_mul_u32_u24 v29, 132, v29
    v_bfi_b32 v25, 15, v13, v25
    v_lshrrev_b32 v26, 12, v26
    v_mul_u32_u24 v30, 132, v30
    v_bfi_b32 v26, 15, v14, v26
    v_lshrrev_b32 v27, 12, v27
    v_mul_u32_u24 v31, 132, v31
    v_bfi_b32 v27, 15, v15, v27
    s_mov_b32 s70, 0xffff0000
    s_mov_b64 exec, s[52:53]
    s_waitcnt lgkmcnt(4)
    v_cmp_le_u32 vcc, 12, v32
    v_cmp_gt_u32 s[6:7], 24, v32
    v_and_b32 v4, 3, v32
    v_lshrrev_b32 v2, 2, v32
    v_cndmask_b32 v3, 0, 61, vcc
    v_lshl_add_u32 v4, v4, 4, v28
    s_mov_b64 exec, s[6:7]
    v_add3_u32 v5, v4, v3, v2
    v_cndmask_b32 v3, 0, 52, vcc
    v_lshl_add_u32 v4, v2, 2, v4
    ds_write_b8 v5, v24 offset:12
    v_add_u32 v36, v4, v3
    s_mov_b64 exec, s[54:55]
    s_waitcnt lgkmcnt(4)
    v_cmp_le_u32 vcc, 12, v33
    v_cmp_gt_u32 s[8:9], 24, v33
    v_and_b32 v4, 3, v33
    v_lshrrev_b32 v2, 2, v33
    v_cndmask_b32 v3, 0, 61, vcc
    v_lshl_add_u32 v4, v4, 4, v29
    s_mov_b64 exec, s[8:9]
    v_add3_u32 v5, v4, v3, v2
    v_cndmask_b32 v3, 0, 52, vcc
    v_lshl_add_u32 v4, v2, 2, v4
    ds_write_b8 v5, v25 offset:12
    v_add_u32 v37, v4, v3
    s_mov_b64 exec, s[56:57]
    s_waitcnt lgkmcnt(4)
    v_cmp_le_u32 vcc, 12, v34
    v_cmp_gt_u32 s[10:11], 24, v34
    v_and_b32 v4, 3, v34
    v_lshrrev_b32 v2, 2, v34
    v_cndmask_b32 v3, 0, 61, vcc
    v_lshl_add_u32 v4, v4, 4, v30
    s_mov_b64 exec, s[10:11]
    v_add3_u32 v5, v4, v3, v2
    v_cndmask_b32 v3, 0, 52, vcc
    v_lshl_add_u32 v4, v2, 2, v4
    ds_write_b8 v5, v26 offset:12
    v_add_u32 v38, v4, v3
    s_mov_b64 exec, s[58:59]
    s_waitcnt lgkmcnt(4)
    v_cmp_le_u32 vcc, 12, v35
    v_cmp_gt_u32 s[62:63], 24, v35
    v_and_b32 v4, 3, v35
    v_lshrrev_b32 v2, 2, v35
    v_cndmask_b32 v3, 0, 61, vcc
    v_lshl_add_u32 v4, v4, 4, v31
    s_mov_b64 exec, s[62:63]
    v_add3_u32 v5, v4, v3, v2
    v_cndmask_b32 v3, 0, 52, vcc
    v_lshl_add_u32 v4, v2, 2, v4
    ds_write_b8 v5, v27 offset:12
    v_add_u32 v39, v4, v3
    s_andn2_b64 s[52:53], s[52:53], s[6:7]
    s_andn2_b64 s[54:55], s[54:55], s[8:9]
    s_andn2_b64 s[56:57], s[56:57], s[10:11]
    s_andn2_b64 s[58:59], s[58:59], s[62:63]
    s_or_b64 s[60:61], s[52:53], s[54:55]
    s_or_b64 s[76:77], s[56:57], s[58:59]
    s_or_b64 s[60:61], s[60:61], s[76:77]
    s_mov_b64 exec, s[72:73]
    s_cmp_eq_u32 s3, 12
    s_waitcnt vmcnt(3)
    s_cbranch_scc1 A_ALL
    s_waitcnt vmcnt(0)
A_ALL:
    v_lshl_or_b32 v16, v20, 16, v16
    v_and_or_b32 v17, v20, s70, v17
    v_lshl_or_b32 v18, v21, 16, v18
    v_and_or_b32 v19, v21, s70, v19
    s_mov_b64 exec, s[6:7]
    ds_write_b32 v36, v16
    s_mov_b64 exec, s[8:9]
    ds_write_b32 v37, v17
    s_mov_b64 exec, s[10:11]
    ds_write_b32 v38, v18
    s_mov_b64 exec, s[62:63]
    ds_write_b32 v39, v19
    s_cmp_lg_u64 s[60:61], 0
    s_cbranch_scc1 A_OVER
A_OUT:
    s_setprio 2
    s_mov_b64 exec, -1
    s_waitcnt lgkmcnt(0)
    s_barrier
    ds_read_u16 v120, v50 offset:38016
A_O1:
    ds_read_b32 v21, v49 offset:38032
    ds_read_u8 v127, v10 offset:38016
    ds_read2_b32 v[12:13], v40 offset0:0 offset1:1
    ds_read2_b32 v[14:15], v40 offset0:2 offset1:3
    ds_read2_b32 v[16:17], v41 offset0:0 offset1:1
    ds_read2_b32 v[18:19], v41 offset0:2 offset1:3
    s_waitcnt lgkmcnt(5)
    v_and_b32 v2, v21, v42
    v_and_b32 v3, v21, v44
    v_bcnt_u32_b32 v2, v2, v46
    v_cmp_eq_u32 s[52:53], v3, v44
    v_lshl_add_u32 v42, v2, 6, v48
    v_and_b32 v2, v21, v43
    v_and_b32 v3, v21, v45
    v_bcnt_u32_b32 v2, v2, v47
    v_cmp_eq_u32 s[54:55], v3, v45
    v_lshl_add_u32 v43, v2, 6, v48
    s_waitcnt lgkmcnt(4)
    v_lshlrev_b32 v20, 24, v127
    s_waitcnt lgkmcnt(2)
    v_and_or_b32 v15, v15, s64, v20
    s_mov_b64 exec, s[52:53]
    buffer_store_dwordx4 v[12:15], v42, s[32:35], s74 offen sc1
    s_mov_b64 exec, s[54:55]
    s_waitcnt lgkmcnt(0)
    v_and_or_b32 v19, v19, s64, v20
    buffer_store_dwordx4 v[16:19], v43, s[32:35], s74 offen sc1
    s_mov_b64 exec, -1
    s_setprio 0
    ds_read_b32 v125, v6 offset:38016
    s_and_b32 s29, s2, 7
    s_and_b32 s27, s29, 3
    s_mul_i32 s27, s27, 12502
    s_sub_u32 s27, 0x10000, s27
    s_lshr_b32 s30, s29, 1
    s_lshl_b32 s30, s30, 15
    s_add_u32 s30, s30, 8388608
    s_add_u32 s31, s30, 16384
    s_lshl_b32 s29, s29, 12
    s_lshr_b32 s26, s2, 3
    s_bfm_b32 s49, s26, 0
    s_mov_b32 s2, s65
    v_mov_b32 v99, 0xf0
    v_mov_b32 v124, 7
    s_mov_b32 s0, 106752
    s_mov_b32 s1, 0x07060302
    s_mov_b32 s71, 0
    s_cmp_eq_u32 s3, 1
    s_cselect_b32 s28, 3, 0x7fff
    v_lshlrev_b32 v2, 2, v0
    v_add_u32 v2, 106752, v2
    v_mov_b32 v3, 0
    v_cmp_gt_u32 vcc, 544, v0
    s_and_saveexec_b64 s[76:77], vcc
    ds_write_b32 v2, v3
    s_mov_b64 exec, -1
    v_lshrrev_b32 v9, 3, v0
    v_lshlrev_b32 v93, 7, v9
    v_lshlrev_b32 v9, 15, v9
    v_lshl_add_u32 v9, v10, 4, v9
    v_lshl_add_u32 v93, v10, 4, v93
    s_add_u32 s36, s18, 41943040
    s_addc_u32 s37, s19, 0
    s_mov_b32 s38, 8388608
    s_mov_b32 s39, s23
    s_sub_u32 s40, s4, 3072
    s_subb_u32 s41, s5, 0
    s_mov_b32 s42, 6403072
    s_mov_b32 s43, s23
    s_add_u32 s44, s18, 12582912
    s_addc_u32 s45, s19, 0
    s_mov_b32 s46, 12812288
    s_mov_b32 s47, s23
    s_mov_b64 s[20:21], s[14:15]
    s_mov_b32 s22, 6400000
    s_add_u32 s24, s18, 12579840
    s_addc_u32 s25, s19, 0
    s_setprio 3
    s_waitcnt vmcnt(0) lgkmcnt(0)
    s_barrier
COLLECT:
    buffer_load_dwordx4 v[20:23], v93, s[32:35], s30 offen sc1
    buffer_load_dwordx4 v[24:27], v93, s[32:35], s31 offen sc1
    s_mov_b32 s68, s29
    s_add_u32 s69, s68, 4194304
    s_mov_b32 s75, 20000000
    v_cmp_gt_u32 s[8:9], 4, v10
    s_bitcmp1_b32 s29, 12
    s_cselect_b64 s[82:83], -1, 0
    v_and_b32 v2, 63, v0
    v_bfe_u32 v3, v2, 4, 1
    v_cmp_eq_u32 s[16:17], 1, v3
    v_xor_b32 v30, v3, v10
    v_lshlrev_b32 v83, 4, v30
    v_add_u32 v80, 3072, v83
    v_add_u32 v82, 1024, v83
    v_xor_b32 v83, 64, v83
    v_add_u32 v81, 2048, v83
    v_and_b32 v92, 15, v0
    v_lshrrev_b32 v11, 4, v2
    v_bfe_u32 v28, v2, 2, 2
    v_and_b32 v29, 3, v2
    v_lshl_add_u32 v84, v11, 3, v28
    v_lshlrev_b32 v84, 7, v84
    v_lshrrev_b32 v28, 1, v28
    v_lshl_or_b32 v28, v3, 2, v28
    v_xor_b32 v28, v28, v29
    v_lshl_add_u32 v84, v28, 4, v84
    v_and_b32 v30, 1, v29
    s_lshl_b32 s76, s3, 12
    v_lshl_add_u32 v84, v30, 3, v84
    s_mov_b32 m0, s76
    v_add_u32 v122, 108928, v84
    v_add_u32 v84, s76, v84
    s_mul_i32 s76, s3, 2560
    v_xor_b32 v85, 8, v84
    v_xor_b32 v86, 64, v84
    v_xor_b32 v87, 72, v84
    s_add_u32 s76, s76, 65536
    v_lshrrev_b32 v30, 3, v2
    v_lshl_add_u32 v88, v30, 2, s76
    v_lshl_add_u32 v123, v2, 2, s76
    s_add_u32 s76, s76, 1280
    v_lshl_add_u32 v89, v11, 5, s76
    v_sub_u32 v95, 0, v29
    v_sub_u32 v96, 1, v29
    v_sub_u32 v97, 2, v29
    v_ashrrev_i32 v95, 31, v95
    v_ashrrev_i32 v96, 31, v96
    v_ashrrev_i32 v97, 31, v97
    v_lshrrev_b32 v30, 2, v2
    v_mul_u32_u24 v98, 2560, v30
    v_add_u32 v98, 65536, v98
    v_lshl_add_u32 v90, v2, 4, s0
    s_lshl_b32 s76, s2, 4
    s_add_u32 s76, s76, s3
    s_mul_i32 s77, s76, 50006
    s_lshr_b32 s77, s77, 12
    v_subrev_u32 v2, s77, v92
    v_and_b32 v2, 15, v2
    v_add_u32 v2, s77, v2
    v_mul_u32_u24 v3, 5368, v2
    v_lshrrev_b32 v3, 16, v3
    v_cmp_eq_u32 s[14:15], s76, v3
    v_lshlrev_b32 v2, 7, v2
    v_lshl_add_u32 v121, v11, 4, v2
    s_waitcnt vmcnt(0)
C_CHK2:
    v_cndmask_b32 v4, v20, v22, s[82:83]
    v_cndmask_b32 v5, v24, v26, s[82:83]
    v_cmp_ne_u32_sdwa vcc, v21, v120 src0_sel:WORD_1 src1_sel:DWORD
    v_cmp_ne_u32_sdwa s[76:77], v23, v120 src0_sel:WORD_1 src1_sel:DWORD
    v_cmp_ne_u32_sdwa s[4:5], v25, v120 src0_sel:WORD_1 src1_sel:DWORD
    v_cmp_ne_u32_sdwa s[6:7], v27, v120 src0_sel:WORD_1 src1_sel:DWORD
    v_mov_b32_dpp v4, v4 quad_perm:[3,3,3,3] row_mask:0xf bank_mask:0xf
    v_mov_b32_dpp v5, v5 quad_perm:[3,3,3,3] row_mask:0xf bank_mask:0xf
    s_or_b64 vcc, vcc, s[76:77]
    s_or_b64 s[4:5], s[4:5], s[6:7]
    s_or_b64 vcc, vcc, s[4:5]
    s_cbranch_scc1 C_RETRY2
C_OK2:
    v_mov_b32_dpp v4, v4 row_half_mirror row_mask:0xf bank_mask:0x5
    v_mov_b32_dpp v5, v5 row_half_mirror row_mask:0xf bank_mask:0x5
    v_and_b32 v2, s49, v4
    v_bfe_u32 v3, v4, s26, 1
    v_bcnt_u32_b32 v2, v2, s26
    v_cmp_eq_u32 vcc, 1, v3
    v_lshl_add_u32 v6, v2, 6, v9
    s_or_b64 exec, vcc, s[8:9]
    buffer_load_dwordx4 v[12:15], v6, s[32:35], s68 offen sc1
    s_mov_b64 s[62:63], exec
    s_mov_b64 exec, -1
    v_and_b32 v2, s49, v5
    v_bfe_u32 v3, v5, s26, 1
    v_bcnt_u32_b32 v2, v2, s26
    v_cmp_eq_u32 vcc, 1, v3
    v_lshl_add_u32 v7, v2, 6, v9
    s_or_b64 exec, vcc, s[8:9]
    buffer_load_dwordx4 v[16:19], v7, s[32:35], s69 offen sc1
    s_mov_b64 s[10:11], exec
    s_mov_b64 exec, -1
    s_setprio 0
    s_cmp_lg_u32 s71, 0
    s_cbranch_scc1 LATE_D
    s_mov_b64 s[12:13], 0
    s_cmp_lt_u32 s3, 12
    s_cbranch_scc1 S_DONE
    s_waitcnt vmcnt(2)
    v_cmp_eq_u32 vcc, v112, v115
    v_cmp_eq_u32 s[76:77], v113, v115
    v_lshlrev_b32 v3, 16, v114
    v_and_b32 v2, 255, v0
    v_or_b32 v113, v3, v113
    s_and_b64 s[12:13], s[66:67], vcc
    s_and_b64 vcc, s[12:13], s[76:77]
    s_andn2_b64 s[12:13], s[12:13], s[76:77]
    v_lshlrev_b32 v2, 2, v2
    v_cndmask_b32 v3, 0, v3, vcc
    v_add_u32 v2, 117120, v2
    ds_write_b32 v2, v3
    s_cbranch_scc0 S_NT
    v_add_u32 v2, s27, v113
    v_and_b32_sdwa v3, v0, v99 dst_sel:DWORD dst_unused:UNUSED_PAD src0_sel:BYTE_0 src1_sel:DWORD
    v_bfe_u32 v2, v2, 12, 4
    v_or_b32 v2, v2, v3
    v_lshl_add_u32 v46, v2, 2, s0
    v_lshlrev_b32_sdwa v54, v124, v113 dst_sel:DWORD dst_unused:UNUSED_PAD src0_sel:DWORD src1_sel:WORD_0
    v_mov_b32 v62, v113
    v_lshlrev_b16_sdwa v62, v0, v1 dst_sel:WORD_0 dst_unused:UNUSED_PRESERVE src0_sel:BYTE_0 src1_sel:DWORD
S_NT:
    s_cmp_eq_u32 s3, 12
    s_cbranch_scc1 S_DONE
    v_subrev_u32 v2, 832, v0
    v_bfe_u32 v3, v2, 4, 1
    v_bfe_u32 v28, v2, 6, 1
    v_lshl_or_b32 v3, v28, 2, v3
    v_cmp_gt_u32 vcc, 128, v2
    v_lshrrev_b32 v28, 1, v10
    v_xor_b32 v3, v3, v28
    v_lshrrev_b32 v2, 3, v2
    v_lshl_add_u32 v2, v2, 3, v3
    v_and_b32 v3, 3, v10
    v_lshl_add_u32 v2, v2, 2, v3
    v_lshlrev_b32 v2, 2, v2
    v_add_u32 v2, 108928, v2
    v_xor_b32 v3, 8, v2
    v_xor_b32 v28, 64, v2
    v_xor_b32 v29, 72, v2
    s_mov_b32 s76, 0x05040100
    v_perm_b32 v64, v102, v100, s76
    v_perm_b32 v65, v102, v100, s1
    v_perm_b32 v66, v103, v101, s76
    v_perm_b32 v67, v103, v101, s1
    ds_write_b32 v2, v64 offset:0
    ds_write_b32 v3, v65 offset:0
    ds_write_b32 v28, v66 offset:0
    ds_write_b32 v29, v67 offset:0
    v_perm_b32 v64, v106, v104, s76
    v_perm_b32 v65, v106, v104, s1
    v_perm_b32 v66, v107, v105, s76
    v_perm_b32 v67, v107, v105, s1
    ds_write_b32 v28, v64 offset:3072
    ds_write_b32 v29, v65 offset:3072
    ds_write_b32 v2, v66 offset:3072
    ds_write_b32 v3, v67 offset:3072
    s_mov_b64 exec, vcc
    v_perm_b32 v64, v110, v108, s76
    v_perm_b32 v65, v110, v108, s1
    v_perm_b32 v66, v111, v109, s76
    v_perm_b32 v67, v111, v109, s1
    ds_write_b32 v2, v64 offset:6144
    ds_write_b32 v3, v65 offset:6144
    ds_write_b32 v28, v66 offset:6144
    ds_write_b32 v29, v67 offset:6144
    s_mov_b64 exec, -1
S_DONE:
LATE_D:
    s_lshl_b32 s76, s2, 4
    s_add_u32 s76, s76, s3
    s_mul_i32 s76, s76, 50006
    s_lshr_b32 s76, s76, 12
    s_not_b32 s77, s14
    v_lshlrev_b32 v28, 2, v11
    v_lshrrev_b32 v29, v28, s77
    v_subrev_u32 v28, s76, v28
    s_lshl_b32 s76, s76, 7
    v_lshl_add_u32 v30, v92, 3, s76
    v_add_u32 v2, 0, v28
    v_bfe_u32 v3, v29, 0, 1
    v_and_b32 v2, 15, v2
    v_lshl_add_u32 v2, v2, 7, v30
    v_lshl_or_b32 v116, v3, 30, v2
    v_add_u32 v2, 1, v28
    v_bfe_u32 v3, v29, 1, 1
    v_and_b32 v2, 15, v2
    v_lshl_add_u32 v2, v2, 7, v30
    v_lshl_or_b32 v117, v3, 30, v2
    v_add_u32 v2, 2, v28
    v_bfe_u32 v3, v29, 2, 1
    v_and_b32 v2, 15, v2
    v_lshl_add_u32 v2, v2, 7, v30
    v_lshl_or_b32 v118, v3, 30, v2
    v_add_u32 v2, 3, v28
    v_bfe_u32 v3, v29, 3, 1
    v_and_b32 v2, 15, v2
    v_lshl_add_u32 v2, v2, 7, v30
    v_lshl_or_b32 v119, v3, 30, v2
    v_and_b32 v21, 0xffff, v21
    v_and_b32 v25, 0xffff, v25
    v_mul_u32_u24 v2, 5368, v21
    v_mul_u32_u24 v3, 5368, v25
    v_cmp_eq_u32 s[8:9], 7, v10
    s_mov_b32 s76, 61447
    v_cmp_lt_u32 s[72:73], s76, v21
    v_cmp_lt_u32 vcc, s76, v25
    v_lshrrev_b32 v2, 20, v2
    v_lshrrev_b32 v3, 20, v3
    v_cmp_eq_u32 s[4:5], s2, v2
    v_cmp_eq_u32 s[6:7], s2, v3
    s_and_b64 s[72:73], s[72:73], s[8:9]
    s_and_b64 vcc, vcc, s[8:9]
    s_lshr_b64 s[72:73], s[72:73], 1
    s_or_b64 s[72:73], s[72:73], vcc
    s_mov_b64 s[66:67], 0
    s_movk_i32 s70, 0xffff
    s_mov_b64 s[64:65], s[12:13]
    s_mov_b64 exec, s[12:13]
    s_cbranch_execz C_NT
    ds_add_rtn_u32 v38, v46, v1
C_NT:
    s_mov_b64 exec, s[62:63]
    s_waitcnt vmcnt(1)
C_CHK0:
    v_cmp_ne_u32_sdwa vcc, v15, v127 src0_sel:BYTE_3 src1_sel:DWORD
    s_cbranch_vccnz C_RETRY0
C_OK0:
    v_cmp_ne_u16 s[52:53], s70, v12
    v_cmp_ne_u16 s[54:55], s70, v13
    v_cmp_ne_u16 s[56:57], s70, v14
    v_add_u32 v2, s27, v12
    v_and_b32_sdwa v3, v15, v99 dst_sel:DWORD dst_unused:UNUSED_PAD src0_sel:BYTE_0 src1_sel:DWORD
    v_bfe_u32 v2, v2, 12, 4
    v_or_b32 v2, v2, v3
    v_lshl_add_u32 v40, v2, 2, s0
    v_add_u32 v2, s27, v13
    v_and_b32_sdwa v3, v15, v99 dst_sel:DWORD dst_unused:UNUSED_PAD src0_sel:BYTE_1 src1_sel:DWORD
    v_bfe_u32 v2, v2, 12, 4
    v_or_b32 v2, v2, v3
    v_lshl_add_u32 v41, v2, 2, s0
    v_add_u32 v2, s27, v14
    v_and_b32_sdwa v3, v15, v99 dst_sel:DWORD dst_unused:UNUSED_PAD src0_sel:BYTE_2 src1_sel:DWORD
    v_bfe_u32 v2, v2, 12, 4
    v_or_b32 v2, v2, v3
    v_lshl_add_u32 v42, v2, 2, s0
    s_mov_b64 exec, s[52:53]
    ds_add_rtn_u32 v32, v40, v1
    s_mov_b64 exec, s[54:55]
    ds_add_rtn_u32 v33, v41, v1
    s_mov_b64 exec, s[56:57]
    ds_add_rtn_u32 v34, v42, v1
    s_mov_b64 exec, s[10:11]
    s_waitcnt vmcnt(0)
C_CHK1:
    v_cmp_ne_u32_sdwa vcc, v19, v127 src0_sel:BYTE_3 src1_sel:DWORD
    s_cbranch_vccnz C_RETRY1
C_OK1:
    v_cmp_ne_u16 s[58:59], s70, v16
    v_cmp_ne_u16 s[60:61], s70, v17
    v_cmp_ne_u16 s[62:63], s70, v18
    v_add_u32 v2, s27, v16
    v_and_b32_sdwa v3, v19, v99 dst_sel:DWORD dst_unused:UNUSED_PAD src0_sel:BYTE_0 src1_sel:DWORD
    v_bfe_u32 v2, v2, 12, 4
    v_or_b32 v2, v2, v3
    v_lshl_add_u32 v43, v2, 2, s0
    v_add_u32 v2, s27, v17
    v_and_b32_sdwa v3, v19, v99 dst_sel:DWORD dst_unused:UNUSED_PAD src0_sel:BYTE_1 src1_sel:DWORD
    v_bfe_u32 v2, v2, 12, 4
    v_or_b32 v2, v2, v3
    v_lshl_add_u32 v44, v2, 2, s0
    v_add_u32 v2, s27, v18
    v_and_b32_sdwa v3, v19, v99 dst_sel:DWORD dst_unused:UNUSED_PAD src0_sel:BYTE_2 src1_sel:DWORD
    v_bfe_u32 v2, v2, 12, 4
    v_or_b32 v2, v2, v3
    v_lshl_add_u32 v45, v2, 2, s0
    s_mov_b64 exec, s[58:59]
    ds_add_rtn_u32 v35, v43, v1
    s_mov_b64 exec, s[60:61]
    ds_add_rtn_u32 v36, v44, v1
    s_mov_b64 exec, s[62:63]
    ds_add_rtn_u32 v37, v45, v1
    s_mov_b64 exec, -1
    s_or_b32 s71, s71, 32
    s_mov_b64 s[68:69], 0
    s_mov_b64 s[82:83], 0
    s_mov_b64 s[84:85], 0
    s_or_b64 s[76:77], s[4:5], s[6:7]
    s_or_b64 s[76:77], s[76:77], s[72:73]
    s_cbranch_scc1 EXTRA0
CDONE:
    s_lshl_b32 s75, s3, 2
    s_add_u32 s75, s75, 3
    s_waitcnt lgkmcnt(0)
    s_barrier
    ds_read_b128 v[4:7], v90
    s_bitcmp1_b32 s71, 3
    s_cbranch_scc1 NOOWN
    s_mov_b64 exec, s[14:15]
    buffer_load_dwordx4 v[64:67], v121, s[40:43], 0 offen offset:3072
    buffer_load_dwordx4 v[68:71], v121, s[40:43], 0 offen offset:3136
NOOWN:
    s_mov_b64 exec, -1
    s_cmp_lg_u32 s3, 15
    s_cbranch_scc1 PT_D
    s_lshl_b32 s76, s2, 8
    s_add_u32 s76, s76, 8519680
    v_lshlrev_b32 v2, 7, v92
    s_mov_b64 exec, 3
    buffer_load_dword v91, v2, s[32:35], s76 offen sc1
    s_mov_b64 exec, -1
PT_D:
    s_bitcmp0_b32 s71, 5
    s_cbranch_scc1 DD_D
    s_andn2_b32 s71, s71, 32
    v_lshlrev_b32_sdwa v48, v124, v12 dst_sel:DWORD dst_unused:UNUSED_PAD src0_sel:DWORD src1_sel:WORD_0
    v_mov_b32 v56, v12
    v_lshlrev_b16_sdwa v56, v15, v1 dst_sel:WORD_0 dst_unused:UNUSED_PRESERVE src0_sel:BYTE_0 src1_sel:DWORD
    v_lshlrev_b32_sdwa v49, v124, v13 dst_sel:DWORD dst_unused:UNUSED_PAD src0_sel:DWORD src1_sel:WORD_0
    v_mov_b32 v57, v13
    v_lshlrev_b16_sdwa v57, v15, v1 dst_sel:WORD_0 dst_unused:UNUSED_PRESERVE src0_sel:BYTE_1 src1_sel:DWORD
    v_lshlrev_b32_sdwa v50, v124, v14 dst_sel:DWORD dst_unused:UNUSED_PAD src0_sel:DWORD src1_sel:WORD_0
    v_mov_b32 v58, v14
    v_lshlrev_b16_sdwa v58, v15, v1 dst_sel:WORD_0 dst_unused:UNUSED_PRESERVE src0_sel:BYTE_2 src1_sel:DWORD
    v_lshlrev_b32_sdwa v51, v124, v16 dst_sel:DWORD dst_unused:UNUSED_PAD src0_sel:DWORD src1_sel:WORD_0
    v_mov_b32 v59, v16
    v_lshlrev_b16_sdwa v59, v19, v1 dst_sel:WORD_0 dst_unused:UNUSED_PRESERVE src0_sel:BYTE_0 src1_sel:DWORD
    v_lshlrev_b32_sdwa v52, v124, v17 dst_sel:DWORD dst_unused:UNUSED_PAD src0_sel:DWORD src1_sel:WORD_0
    v_mov_b32 v60, v17
    v_lshlrev_b16_sdwa v60, v19, v1 dst_sel:WORD_0 dst_unused:UNUSED_PRESERVE src0_sel:BYTE_1 src1_sel:DWORD
    v_lshlrev_b32_sdwa v53, v124, v18 dst_sel:DWORD dst_unused:UNUSED_PAD src0_sel:DWORD src1_sel:WORD_0
    v_mov_b32 v61, v18
    v_lshlrev_b16_sdwa v61, v19, v1 dst_sel:WORD_0 dst_unused:UNUSED_PRESERVE src0_sel:BYTE_2 src1_sel:DWORD
DD_D:
    s_waitcnt lgkmcnt(0)
    v_add_u32 v5, v4, v5
    v_add3_u32 v7, v5, v6, v7
    v_add_u32 v6, v5, v6
    s_nop 0
    v_and_b32_dpp v28, v7, v95 quad_perm:[0,0,0,0] row_mask:0xf bank_mask:0xf
    v_and_b32_dpp v29, v7, v96 quad_perm:[1,1,1,1] row_mask:0xf bank_mask:0xf
    v_and_b32_dpp v30, v7, v97 quad_perm:[2,2,2,2] row_mask:0xf bank_mask:0xf
    v_add3_u32 v28, v28, v29, v30
    v_add_u32 v7, v28, v7
    v_lshl_add_u32 v28, v28, 2, v98
    v_cmp_lt_u32 vcc, 320, v7
    v_lshl_add_u32 v29, v4, 2, v28
    v_lshl_add_u32 v30, v5, 2, v28
    v_lshl_add_u32 v31, v6, 2, v28
    v_readlane_b32 s74, v7, s75
    ds_write_b128 v90, v[28:31] offset:1024
    s_or_b64 s[76:77], s[64:65], s[66:67]
    s_cbranch_scc0 P_NR
    s_mov_b64 exec, s[64:65]
    ds_read_b32 v26, v46 offset:1024
    s_mov_b64 exec, s[66:67]
    ds_read_b32 v27, v47 offset:1024
P_NR:
    s_mov_b64 exec, s[52:53]
    ds_read_b32 v20, v40 offset:1024
    s_mov_b64 exec, s[54:55]
    ds_read_b32 v21, v41 offset:1024
    s_mov_b64 exec, s[56:57]
    ds_read_b32 v22, v42 offset:1024
    s_mov_b64 exec, s[58:59]
    ds_read_b32 v23, v43 offset:1024
    s_mov_b64 exec, s[60:61]
    ds_read_b32 v24, v44 offset:1024
    s_mov_b64 exec, s[62:63]
    ds_read_b32 v25, v45 offset:1024
    s_min_u32 s74, s74, 320
    s_cbranch_vccnz SLOWW
    s_mov_b64 exec, s[52:53]
    s_waitcnt lgkmcnt(5)
    v_lshl_add_u32 v20, v32, 2, v20
    ds_write2st64_b32 v20, v48, v56 offset0:0 offset1:5
    s_mov_b64 exec, s[54:55]
    s_waitcnt lgkmcnt(5)
    v_lshl_add_u32 v21, v33, 2, v21
    ds_write2st64_b32 v21, v49, v57 offset0:0 offset1:5
    s_mov_b64 exec, s[56:57]
    s_waitcnt lgkmcnt(5)
    v_lshl_add_u32 v22, v34, 2, v22
    ds_write2st64_b32 v22, v50, v58 offset0:0 offset1:5
    s_mov_b64 exec, s[58:59]
    s_waitcnt lgkmcnt(5)
    v_lshl_add_u32 v23, v35, 2, v23
    ds_write2st64_b32 v23, v51, v59 offset0:0 offset1:5
    s_mov_b64 exec, s[60:61]
    s_waitcnt lgkmcnt(5)
    v_lshl_add_u32 v24, v36, 2, v24
    ds_write2st64_b32 v24, v52, v60 offset0:0 offset1:5
    s_mov_b64 exec, s[62:63]
    s_waitcnt lgkmcnt(5)
    v_lshl_add_u32 v25, v37, 2, v25
    ds_write2st64_b32 v25, v53, v61 offset0:0 offset1:5
    s_cmp_eq_u64 s[76:77], 0
    s_cbranch_scc1 P_NW
    s_mov_b64 exec, s[64:65]
    v_lshl_add_u32 v26, v38, 2, v26
    ds_write2st64_b32 v26, v54, v62 offset0:0 offset1:5
    s_mov_b64 exec, s[66:67]
    v_lshl_add_u32 v27, v39, 2, v27
    ds_write2st64_b32 v27, v55, v63 offset0:0 offset1:5
P_NW:
    s_mov_b64 s[52:53], 0
    s_mov_b64 s[54:55], 0
    s_mov_b64 s[56:57], 0
    s_mov_b64 s[58:59], 0
    s_mov_b64 s[60:61], 0
    s_mov_b64 s[62:63], 0
    s_mov_b64 s[64:65], 0
    s_mov_b64 s[66:67], 0
WDONE:
    s_sub_u32 s76, 0, s74
    s_and_b32 s76, s76, 31
    s_bfm_b64 exec, s76, 0
    s_lshl_b32 s77, s74, 2
    v_add_u32 v2, s77, v123
    v_mov_b32 v3, 1073741824
    ds_write2st64_b32 v2, v3, v3 offset0:0 offset1:5
    s_mov_b64 exec, -1
    v_mov_b32 v4, 108800
    s_lshl_b32 s76, s3, 6
    s_add_u32 s76, s76, 117120
    v_lshl_add_u32 v5, v92, 2, s76
    ds_read_b32 v126, v5
    s_waitcnt lgkmcnt(0)
    s_barrier
    ds_read_b32 v8, v4
MAIN:
    s_cmp_eq_u32 s74, 0
    s_cbranch_scc1 EMPTY
    s_bitcmp1_b32 s71, 0
    s_cbranch_scc1 REMAP2
MAIN1:
    ds_read2_b32 v[100:101], v88 offset0:0 offset1:8
    ds_read2_b32 v[102:103], v88 offset0:16 offset1:24
    ds_read_b128 v[104:107], v89
    ds_read_b128 v[108:111], v89 offset:16
    v_add_u32 v93, 128, v88
    v_add_u32 v94, 128, v89
    s_waitcnt lgkmcnt(2)
    v_add_u32 v100, v100, v80
    v_add_u32 v101, v101, v81
    v_add_u32 v102, v102, v82
    v_add_u32 v103, v103, v83
MAIN2:
    buffer_load_dwordx4 v100, s[40:43], 0 offen offset:0  lds
    buffer_load_dwordx4 v101, s[40:43], 0 offen offset:1024  lds
    buffer_load_dwordx4 v102, s[40:43], 0 offen offset:2048  lds
    buffer_load_dwordx4 v103, s[40:43], 0 offen offset:3072  lds
    s_add_u32 s9, s74, 7
    s_lshr_b32 s9, s9, 3
    s_sub_i32 s9, s9, 4
    s_max_i32 s9, s9, 0
    s_mov_b32 s10, 7
    s_mov_b32 s8, 1
    s_lshl_b32 s11, s10, 1
    s_cmp_ge_i32 s9, s11
    s_addc_u32 s8, s8, 0
    s_add_i32 s11, s11, s10
    s_cmp_ge_i32 s9, s11
    s_addc_u32 s8, s8, 0
    s_add_i32 s11, s11, s10
    s_cmp_ge_i32 s9, s11
    s_addc_u32 s8, s8, 0
    s_min_i32 s8, s8, s9
    s_sub_i32 s9, s9, s8
    s_sub_i32 s10, s10, 1
    s_lshl_b32 s11, s8, 5
    s_waitcnt lgkmcnt(0)
    v_bfe_i32 v32, v104, v92, 1
    v_bfe_i32 v33, v105, v92, 1
    v_bfe_i32 v34, v106, v92, 1
    v_bfe_i32 v35, v107, v92, 1
    v_bfe_i32 v36, v108, v92, 1
    v_bfe_i32 v37, v109, v92, 1
    v_bfe_i32 v38, v110, v92, 1
    v_bfe_i32 v39, v111, v92, 1
    v_and_b32 v32, v32, v104
    v_and_b32 v33, v33, v105
    v_and_b32 v34, v34, v106
    v_and_b32 v35, v35, v107
    v_and_b32 v36, v36, v108
    v_and_b32 v37, v37, v109
    v_and_b32 v38, v38, v110
    v_and_b32 v39, v39, v111
    v_perm_b32 v112, v33, v32, s1
    v_perm_b32 v113, v35, v34, s1
    v_perm_b32 v114, v37, v36, s1
    v_perm_b32 v115, v39, v38, s1
    ds_read2_b32 v[100:101], v93 offset0:0 offset1:8
    ds_read2_b32 v[102:103], v93 offset0:16 offset1:24
    ds_read_b128 v[104:107], v94
    ds_read_b128 v[108:111], v94 offset:16
    v_add_u32 v93, s11, v93
    v_add_u32 v94, s11, v94
    s_bitcmp1_b32 s71, 3
    s_cbranch_scc1 LOOP
    s_or_b32 s71, s71, 8
    v_bfe_u32 v2, v121, 13, 2
    v_and_b32 v9, 0xffffe000, v121
    v_cmp_gt_u32 s[78:79], 1, v2
    v_add_u32 v9, v9, v121
    v_lshrrev_b32 v2, 8, v9
    v_and_b32 v2, 0x2000, v2
    v_xor_b32 v9, v9, v2
    s_and_b32 s76, s26, 3
    s_or_b32 s76, s76, s3
    s_cbranch_scc1 PRB_M
    s_or_b32 s71, s71, 64
    s_branch PROBE
PRB_M:
    s_waitcnt vmcnt(4)
PRB_M2:
    s_mov_b64 exec, s[16:17]
    v_swap_b32 v64, v66
    v_swap_b32 v65, v67
    v_swap_b32 v68, v70
    v_swap_b32 v69, v71
    s_mov_b64 exec, -1
    v_and_b32 v79, 0xffff0000, v71
    v_lshlrev_b32 v78, 16, v71
    v_and_b32 v77, 0xffff0000, v70
    v_lshlrev_b32 v76, 16, v70
    v_and_b32 v75, 0xffff0000, v69
    v_lshlrev_b32 v74, 16, v69
    v_and_b32 v73, 0xffff0000, v68
    v_lshlrev_b32 v72, 16, v68
    v_and_b32 v71, 0xffff0000, v67
    v_lshlrev_b32 v70, 16, v67
    v_and_b32 v69, 0xffff0000, v66
    v_lshlrev_b32 v68, 16, v66
    v_and_b32 v67, 0xffff0000, v65
    v_lshlrev_b32 v66, 16, v65
    v_and_b32 v65, 0xffff0000, v64
    v_lshlrev_b32 v64, 16, v64
    v_mul_f32 v64, v126, v64
    v_mul_f32 v65, v126, v65
    v_mul_f32 v66, v126, v66
    v_mul_f32 v67, v126, v67
    v_mul_f32 v68, v126, v68
    v_mul_f32 v69, v126, v69
    v_mul_f32 v70, v126, v70
    v_mul_f32 v71, v126, v71
    v_mul_f32 v72, v126, v72
    v_mul_f32 v73, v126, v73
    v_mul_f32 v74, v126, v74
    v_mul_f32 v75, v126, v75
    v_mul_f32 v76, v126, v76
    v_mul_f32 v77, v126, v77
    v_mul_f32 v78, v126, v78
    v_mul_f32 v79, v126, v79
LOOP:
    s_waitcnt lgkmcnt(2)
    v_add_u32 v100, v100, v80
    v_add_u32 v101, v101, v81
    v_add_u32 v102, v102, v82
    v_add_u32 v103, v103, v83
    v_cmp_gt_u32 vcc, s8, v11
    s_waitcnt vmcnt(0)
    ds_read_b64_tr_b16 v[12:13], v84 offset:0
    ds_read_b64_tr_b16 v[14:15], v84 offset:512
    ds_read_b64_tr_b16 v[16:17], v85 offset:0
    ds_read_b64_tr_b16 v[18:19], v85 offset:512
    ds_read_b64_tr_b16 v[20:21], v86 offset:0
    ds_read_b64_tr_b16 v[22:23], v86 offset:512
    ds_read_b64_tr_b16 v[24:25], v87 offset:0
    ds_read_b64_tr_b16 v[26:27], v87 offset:512
    s_cmp_eq_u32 s8, 0
    v_cndmask_b32 v91, 0, v1, vcc
    s_waitcnt lgkmcnt(0)
    s_cbranch_scc1 LAST
    buffer_load_dwordx4 v100, s[40:43], 0 offen offset:0  lds
    s_cmp_eq_u32 s8, 1
    s_cbranch_scc1 DMAD
    buffer_load_dwordx4 v101, s[40:43], 0 offen offset:1024  lds
    s_cmp_eq_u32 s8, 2
    s_cbranch_scc1 DMAD
    buffer_load_dwordx4 v102, s[40:43], 0 offen offset:2048  lds
    s_cmp_eq_u32 s8, 3
    s_cbranch_scc1 DMAD
    buffer_load_dwordx4 v103, s[40:43], 0 offen offset:3072  lds
DMAD:
    s_cmp_eq_u32 s10, s28
    s_cbranch_scc1 VOTES
VOTED:
    v_mfma_f32_16x16x32_bf16 v[64:67], v[12:15], v[112:115], v[64:67]
    v_mfma_f32_16x16x32_bf16 v[68:71], v[16:19], v[112:115], v[68:71]
    v_mfma_f32_16x16x32_bf16 v[72:75], v[20:23], v[112:115], v[72:75]
    v_mfma_f32_16x16x32_bf16 v[76:79], v[24:27], v[112:115], v[76:79]
    s_mov_b32 s8, 1
    s_lshl_b32 s11, s10, 1
    s_cmp_ge_i32 s9, s11
    s_addc_u32 s8, s8, 0
    s_add_i32 s11, s11, s10
    s_cmp_ge_i32 s9, s11
    s_addc_u32 s8, s8, 0
    s_add_i32 s11, s11, s10
    s_cmp_ge_i32 s9, s11
    s_addc_u32 s8, s8, 0
    s_min_i32 s8, s8, s9
    s_sub_i32 s9, s9, s8
    s_sub_i32 s10, s10, 1
    s_lshl_b32 s11, s8, 5
    v_bfe_i32 v32, v104, v92, v91
    v_bfe_i32 v33, v105, v92, v91
    v_bfe_i32 v34, v106, v92, v91
    v_bfe_i32 v35, v107, v92, v91
    v_bfe_i32 v36, v108, v92, v91
    v_bfe_i32 v37, v109, v92, v91
    v_bfe_i32 v38, v110, v92, v91
    v_bfe_i32 v39, v111, v92, v91
    v_and_b32 v32, v32, v104
    v_and_b32 v33, v33, v105
    v_and_b32 v34, v34, v106
    v_and_b32 v35, v35, v107
    v_and_b32 v36, v36, v108
    v_and_b32 v37, v37, v109
    v_and_b32 v38, v38, v110
    v_and_b32 v39, v39, v111
    v_perm_b32 v112, v33, v32, s1
    v_perm_b32 v113, v35, v34, s1
    v_perm_b32 v114, v37, v36, s1
    v_perm_b32 v115, v39, v38, s1
    ds_read2_b32 v[100:101], v93 offset0:0 offset1:8
    ds_read2_b32 v[102:103], v93 offset0:16 offset1:24
    ds_read_b128 v[104:107], v94
    ds_read_b128 v[108:111], v94 offset:16
    v_add_u32 v93, s11, v93
    v_add_u32 v94, s11, v94
    s_branch LOOP
LAST:
    v_mfma_f32_16x16x32_bf16 v[64:67], v[12:15], v[112:115], v[64:67]
    v_mfma_f32_16x16x32_bf16 v[68:71], v[16:19], v[112:115], v[68:71]
    v_mfma_f32_16x16x32_bf16 v[72:75], v[20:23], v[112:115], v[72:75]
    v_mfma_f32_16x16x32_bf16 v[76:79], v[24:27], v[112:115], v[76:79]
MAINDONE:
    v_mov_b32 v7, 108864
    ds_read_b32 v7, v7
    v_readfirstlane_b32 s75, v8
    s_cmp_lg_u32 s75, 0
    s_cbranch_scc1 AGAIN
    s_nop 2
    v_cvt_pk_bf16_f32 v12, v64, v65
    v_cvt_pk_bf16_f32 v13, v66, v67
    v_cvt_pk_bf16_f32 v14, v68, v69
    v_cvt_pk_bf16_f32 v15, v70, v71
    v_cvt_pk_bf16_f32 v16, v72, v73
    v_cvt_pk_bf16_f32 v17, v74, v75
    v_cvt_pk_bf16_f32 v18, v76, v77
    v_cvt_pk_bf16_f32 v19, v78, v79
    s_mov_b64 exec, s[16:17]
    v_swap_b32 v12, v14
    v_swap_b32 v13, v15
    v_swap_b32 v16, v18
    v_swap_b32 v17, v19
    s_bitcmp1_b32 s71, 0
    s_cbranch_scc1 FINAL
    s_mov_b64 exec, -1
    s_waitcnt lgkmcnt(0)
    v_readfirstlane_b32 s80, v7
    s_and_b32 s81, s2, 1
    s_cmp_eq_u32 s80, 0
    s_cbranch_scc1 E_NOC
E_HAVEC:
    s_xor_b32 s80, s80, s81
    s_and_b32 s80, s80, 1
    s_lshl_b32 s80, s80, 13
    v_xor_b32 v9, s80, v9
    s_mov_b64 exec, s[14:15]
    buffer_store_dwordx4 v[12:15], v9, s[44:47], 0 offen sc1
    buffer_store_dwordx4 v[16:19], v9, s[44:47], 0 offen offset:64 sc1
    v_xor_b32 v20, 0x2000, v9
    s_and_b64 exec, exec, s[78:79]
    s_cbranch_execz E_NOREP
    buffer_store_dwordx4 v[12:15], v20, s[44:47], 0 offen sc1
    buffer_store_dwordx4 v[16:19], v20, s[44:47], 0 offen offset:64 sc1
E_NOREP:
    s_setprio 0
    s_mov_b64 exec, -1
    s_mov_b64 s[40:41], s[24:25]
    s_mov_b32 s42, 12815360
    s_or_b32 s71, s71, 1
    s_lshr_b32 s76, s2, 2
    s_lshl_b32 s76, s76, 7
    s_and_b32 s77, s2, 3
    s_lshl_b32 s77, s77, 2
    s_add_u32 s76, s76, s77
    s_add_u32 s76, s76, 8519680
    v_lshlrev_b32 v2, 13, v0
    s_getreg_b32 s77, hwreg(HW_REG_XCC_ID, 0, 2)
    s_lshl_b32 s77, s77, 14
    s_add_u32 s77, s77, s80
    s_add_u32 s77, s77, 8519680
    v_lshlrev_b32 v8, 7, v0
    s_waitcnt vmcnt(0)
    s_barrier
    s_cmp_lg_u32 s3, 0
    s_cbranch_scc1 G2_NOF
    s_mov_b64 exec, 0xff
    buffer_store_dword v125, v2, s[32:35], s76 offen sc1
G2_NOF:
    s_mov_b64 exec, -1
    s_cmp_lg_u32 s3, 0
    s_cbranch_scc1 G2_NP
    s_setprio 3
G2_NP:
    s_mov_b64 exec, s[16:17]
    v_swap_b32 v12, v14
    v_swap_b32 v13, v15
    v_swap_b32 v16, v18
    v_swap_b32 v17, v19
    s_mov_b64 exec, -1
    v_and_b32 v79, 0xffff0000, v19
    v_lshlrev_b32 v78, 16, v19
    v_and_b32 v77, 0xffff0000, v18
    v_lshlrev_b32 v76, 16, v18
    v_and_b32 v75, 0xffff0000, v17
    v_lshlrev_b32 v74, 16, v17
    v_and_b32 v73, 0xffff0000, v16
    v_lshlrev_b32 v72, 16, v16
    v_and_b32 v71, 0xffff0000, v15
    v_lshlrev_b32 v70, 16, v15
    v_and_b32 v69, 0xffff0000, v14
    v_lshlrev_b32 v68, 16, v14
    v_and_b32 v67, 0xffff0000, v13
    v_lshlrev_b32 v66, 16, v13
    v_and_b32 v65, 0xffff0000, v12
    v_lshlrev_b32 v64, 16, v12
    v_mul_f32 v64, v126, v64
    v_mul_f32 v65, v126, v65
    v_mul_f32 v66, v126, v66
    v_mul_f32 v67, v126, v67
    v_mul_f32 v68, v126, v68
    v_mul_f32 v69, v126, v69
    v_mul_f32 v70, v126, v70
    v_mul_f32 v71, v126, v71
    v_mul_f32 v72, v126, v72
    v_mul_f32 v73, v126, v73
    v_mul_f32 v74, v126, v74
    v_mul_f32 v75, v126, v75
    v_mul_f32 v76, v126, v76
    v_mul_f32 v77, v126, v77
    v_mul_f32 v78, v126, v78
    v_mul_f32 v79, v126, v79
    s_bitcmp1_b32 s71, 1
    s_cbranch_scc1 E_IRR
    s_or_b32 s71, s71, 16
    v_xor_b32 v5, 8, v122
    v_xor_b32 v6, 64, v122
    v_xor_b32 v7, 72, v122
    ds_read_b64_tr_b16 v[40:41], v122 offset:0
    ds_read_b64_tr_b16 v[42:43], v122 offset:512
    ds_read_b64_tr_b16 v[44:45], v5 offset:0
    ds_read_b64_tr_b16 v[46:47], v5 offset:512
    ds_read_b64_tr_b16 v[48:49], v6 offset:0
    ds_read_b64_tr_b16 v[50:51], v6 offset:512
    ds_read_b64_tr_b16 v[52:53], v7 offset:0
    ds_read_b64_tr_b16 v[54:55], v7 offset:512
    ds_read_b64_tr_b16 v[56:57], v122 offset:4096
    ds_read_b64_tr_b16 v[58:59], v122 offset:4608
    ds_read_b64_tr_b16 v[60:61], v5 offset:4096
    ds_read_b64_tr_b16 v[62:63], v5 offset:4608
    ds_read_b64_tr_b16 v[28:29], v6 offset:4096
    ds_read_b64_tr_b16 v[30:31], v6 offset:4608
    ds_read_b64_tr_b16 v[96:97], v7 offset:4096
    ds_read_b64_tr_b16 v[98:99], v7 offset:4608
    ds_read_b32 v32, v123 offset:0
    ds_read_b32 v33, v123 offset:256
    ds_read_b32 v34, v123 offset:512
    ds_read_b32 v35, v123 offset:768
    ds_read_b32 v36, v123 offset:1024
    v_mov_b32 v37, 5368
    v_mov_b32 v38, 0x2000
    s_lshl_b32 s76, s81, 20
    s_waitcnt lgkmcnt(4)
    v_lshrrev_b32 v2, 7, v32
    v_lshrrev_b32 v39, 1, v32
    v_mad_u32_u24 v3, v2, v37, s76
    v_lshrrev_b32 v3, 7, v3
    v_bitop3_b32 v3, v32, v39, v3 bitop3:0xa8
    v_and_b32 v39, 0xffffe000, v32
    v_bitop3_b32 v3, v3, v2, s80 bitop3:0x96
    v_add_u32 v32, v32, v39
    v_and_or_b32 v32, v3, v38, v32
    ds_write_b32 v123, v32 offset:0
    s_waitcnt lgkmcnt(4)
    v_lshrrev_b32 v2, 7, v33
    v_lshrrev_b32 v39, 1, v33
    v_mad_u32_u24 v3, v2, v37, s76
    v_lshrrev_b32 v3, 7, v3
    v_bitop3_b32 v3, v33, v39, v3 bitop3:0xa8
    v_and_b32 v39, 0xffffe000, v33
    v_bitop3_b32 v3, v3, v2, s80 bitop3:0x96
    v_add_u32 v33, v33, v39
    v_and_or_b32 v33, v3, v38, v33
    ds_write_b32 v123, v33 offset:256
    s_waitcnt lgkmcnt(4)
    v_lshrrev_b32 v2, 7, v34
    v_lshrrev_b32 v39, 1, v34
    v_mad_u32_u24 v3, v2, v37, s76
    v_lshrrev_b32 v3, 7, v3
    v_bitop3_b32 v3, v34, v39, v3 bitop3:0xa8
    v_and_b32 v39, 0xffffe000, v34
    v_bitop3_b32 v3, v3, v2, s80 bitop3:0x96
    v_add_u32 v34, v34, v39
    v_and_or_b32 v34, v3, v38, v34
    ds_write_b32 v123, v34 offset:512
    s_cmpk_le_u32 s74, 192
    s_cbranch_scc1 RW1
    s_waitcnt lgkmcnt(4)
    v_lshrrev_b32 v2, 7, v35
    v_lshrrev_b32 v39, 1, v35
    v_mad_u32_u24 v3, v2, v37, s76
    v_lshrrev_b32 v3, 7, v3
    v_bitop3_b32 v3, v35, v39, v3 bitop3:0xa8
    v_and_b32 v39, 0xffffe000, v35
    v_bitop3_b32 v3, v3, v2, s80 bitop3:0x96
    v_add_u32 v35, v35, v39
    v_and_or_b32 v35, v3, v38, v35
    ds_write_b32 v123, v35 offset:768
    s_cmpk_le_u32 s74, 256
    s_cbranch_scc1 RW1
    s_waitcnt lgkmcnt(4)
    v_lshrrev_b32 v2, 7, v36
    v_lshrrev_b32 v39, 1, v36
    v_mad_u32_u24 v3, v2, v37, s76
    v_lshrrev_b32 v3, 7, v3
    v_bitop3_b32 v3, v36, v39, v3 bitop3:0xa8
    v_and_b32 v39, 0xffffe000, v36
    v_bitop3_b32 v3, v3, v2, s80 bitop3:0x96
    v_add_u32 v36, v36, v39
    v_and_or_b32 v36, v3, v38, v36
    ds_write_b32 v123, v36 offset:1024
RW1:
    ds_read2_b32 v[100:101], v88 offset0:0 offset1:8
    ds_read2_b32 v[102:103], v88 offset0:16 offset1:24
    ds_read_b128 v[104:107], v89
    ds_read_b128 v[108:111], v89 offset:16
    v_add_u32 v93, 128, v88
    v_add_u32 v94, 128, v89
    s_waitcnt lgkmcnt(2)
    v_add_u32 v100, v100, v80
    v_add_u32 v101, v101, v81
    v_add_u32 v102, v102, v82
    v_add_u32 v103, v103, v83
E_BAR:
    s_cmp_lg_u32 s3, 0
    s_cbranch_scc1 G2_WAIT
    s_mov_b32 s75, 20000000
G2_POLL:
    buffer_load_dwordx4 v[4:7], v8, s[32:35], s77 offen sc1
    s_sub_u32 s75, s75, 1
    s_cmp_eq_u32 s75, 0
    s_waitcnt vmcnt(0)
    s_cbranch_scc1 G2_WAIT
    v_xor_b32 v4, v4, v125
    v_xor_b32 v5, v5, v125
    v_xor_b32 v6, v6, v125
    v_xor_b32 v7, v7, v125
    v_or3_b32 v4, v4, v5, v6
    v_or_b32 v4, v4, v7
    v_cmp_ne_u32 vcc, 0, v4
    s_and_b64 exec, exec, vcc
    s_cbranch_scc1 G2_POLL
G2_WAIT:
    s_mov_b64 exec, -1
    s_setprio 0
    v_mov_b32 v8, 0
    s_and_b32 s76, s71, 2
    s_cselect_b32 s76, 0, s74
    s_cmp_lg_u32 s76, 0
    s_barrier
    s_cbranch_scc1 MAIN2
    s_bitcmp0_b32 s71, 1
    s_cbranch_scc1 MAIN
    s_branch COLLECT
FINAL:
    s_mov_b64 exec, -1
    s_bitcmp0_b32 s71, 4
    s_cbranch_scc1 F_GETW
F_HAVEW:
    v_mfma_f32_16x16x32_bf16 v[64:67], v[12:15], v[40:43], 0
    v_mfma_f32_16x16x32_bf16 v[68:71], v[12:15], v[44:47], 0
    v_mfma_f32_16x16x32_bf16 v[72:75], v[12:15], v[48:51], 0
    v_mfma_f32_16x16x32_bf16 v[76:79], v[12:15], v[52:55], 0
    v_mfma_f32_16x16x32_bf16 v[64:67], v[16:19], v[56:59], v[64:67]
    v_mfma_f32_16x16x32_bf16 v[68:71], v[16:19], v[60:63], v[68:71]
    v_mfma_f32_16x16x32_bf16 v[72:75], v[16:19], v[28:31], v[72:75]
    v_mfma_f32_16x16x32_bf16 v[76:79], v[16:19], v[96:99], v[76:79]
    s_nop 5
    v_cvt_pk_bf16_f32 v20, v64, v68
    v_cvt_pk_bf16_f32 v22, v65, v69
    v_cvt_pk_bf16_f32 v24, v66, v70
    v_cvt_pk_bf16_f32 v26, v67, v71
    v_cvt_pk_bf16_f32 v21, v72, v76
    buffer_store_dwordx2 v[20:21], v116, s[20:23], 0 offen sc1 nt
    v_cvt_pk_bf16_f32 v23, v73, v77
    buffer_store_dwordx2 v[22:23], v117, s[20:23], 0 offen sc1 nt
    v_cvt_pk_bf16_f32 v25, v74, v78
    buffer_store_dwordx2 v[24:25], v118, s[20:23], 0 offen sc1 nt
    v_cvt_pk_bf16_f32 v27, v75, v79
    buffer_store_dwordx2 v[26:27], v119, s[20:23], 0 offen sc1 nt
F_ST:
END:
    s_endpgm
C_RETRY0:
    s_lshr_b64 s[76:77], vcc, 1
    s_or_b64 vcc, vcc, s[76:77]
    s_lshr_b64 s[76:77], vcc, 2
    s_or_b64 vcc, vcc, s[76:77]
    s_and_b32 vcc_lo, vcc_lo, 0x11111111
    s_and_b32 vcc_hi, vcc_hi, 0x11111111
    s_mul_i32 exec_lo, vcc_lo, 15
    s_mul_i32 exec_hi, vcc_hi, 15
    buffer_load_dwordx4 v[12:15], v6, s[32:35], s68 offen sc1
    s_mov_b64 exec, s[62:63]
    s_sub_u32 s75, s75, 1
    s_cmp_eq_u32 s75, 0
    s_waitcnt vmcnt(0)
    s_cbranch_scc0 C_CHK0
    s_mov_b32 s75, 1000
    s_branch C_OK0
C_RETRY1:
    s_lshr_b64 s[76:77], vcc, 1
    s_or_b64 vcc, vcc, s[76:77]
    s_lshr_b64 s[76:77], vcc, 2
    s_or_b64 vcc, vcc, s[76:77]
    s_and_b32 vcc_lo, vcc_lo, 0x11111111
    s_and_b32 vcc_hi, vcc_hi, 0x11111111
    s_mul_i32 exec_lo, vcc_lo, 15
    s_mul_i32 exec_hi, vcc_hi, 15
    buffer_load_dwordx4 v[16:19], v7, s[32:35], s69 offen sc1
    s_mov_b64 exec, s[10:11]
    s_sub_u32 s75, s75, 1
    s_cmp_eq_u32 s75, 0
    s_waitcnt vmcnt(0)
    s_cbranch_scc0 C_CHK1
    s_mov_b32 s75, 1000
    s_branch C_OK1
C_RETRY2:
    buffer_load_dwordx4 v[20:23], v93, s[32:35], s30 offen sc1
    buffer_load_dwordx4 v[24:27], v93, s[32:35], s31 offen sc1
    s_sub_u32 s75, s75, 1
    s_cmp_eq_u32 s75, 0
    s_waitcnt vmcnt(0)
    s_cbranch_scc0 C_CHK2
    s_mov_b32 s75, 1000
    s_branch C_OK2
PROBE:
    s_lshr_b32 s76, s29, 12
    s_lshl3_add_u32 s77, s26, s76
    s_lshl_b32 s80, s77, 15
    s_xor_b32 s81, s29, 0x1000
    s_add_u32 s80, s80, s81
    s_xor_b32 s81, s80, 0x2000
    s_xor_b32 s75, s80, 0x4000
    s_load_dword s50, s[18:19], s75
    s_waitcnt lgkmcnt(0)
    s_memtime vcc
    s_load_dword s50, s[18:19], s80
    s_waitcnt lgkmcnt(0)
    s_memtime s[76:77]
    s_load_dword s50, s[18:19], s81
    s_waitcnt lgkmcnt(0)
    s_sub_u32 s75, s76, vcc_lo
    s_memtime vcc
    s_waitcnt lgkmcnt(0)
    s_sub_u32 s77, vcc_lo, s76
    s_cmp_lt_u32 s75, s77
    s_cselect_b32 s80, s80, s81
    s_lshr_b32 s81, s80, 8
    s_xor_b32 s80, s80, s81
    s_lshr_b32 s80, s80, 13
    s_xor_b32 s80, s80, s2
    s_and_b32 s80, s80, 1
    s_lshr_b32 s76, s29, 12
    s_lshr_b32 s77, s26, 2
    s_lshl3_add_u32 s77, s77, s76
    s_lshl_b32 s77, s77, 7
    s_add_u32 s77, s77, 8585216
    v_lshlrev_b32 v2, 3, v0
    v_mov_b32 v4, v125
    v_mov_b32 v5, s80
    s_mov_b64 exec, 0xffff
    buffer_store_dwordx2 v[4:5], v2, s[32:35], s77 offen sc1
    s_mov_b64 exec, -1
    s_bitcmp0_b32 s71, 6
    s_cbranch_scc1 PRB_E
    s_sub_u32 s10, s10, 1
    s_waitcnt vmcnt(5)
    s_branch PRB_M2
VOTES:
    s_sub_u32 s28, s28, 1
    s_bitcmp1_b32 s71, 7
    s_cbranch_scc0 VOTEL
    v_cmp_ne_u32 vcc, v4, v125
    s_cbranch_vccnz VOTEL
    v_cmp_eq_u32 vcc, 1, v5
    s_bcnt1_i32_b64 s76, vcc
    s_cmp_ge_u32 s76, 32
    s_cselect_b32 s76, 3, 2
    v_mov_b32 v2, 108864
    v_mov_b32 v3, s76
    ds_write_b32 v2, v3
    s_movk_i32 s28, 0x7fff
    s_branch VOTED
VOTEL:
    s_or_b32 s71, s71, 128
    v_and_b32 v2, 63, v0
    v_lshlrev_b32 v2, 7, v2
    s_mov_b32 s76, 8585216
    buffer_load_dwordx2 v[4:5], v2, s[32:35], s76 offen sc1
    s_branch VOTED
E_NOC:
    s_mov_b32 s75, 20000000
    s_cmp_lg_u32 s3, 1
    s_cbranch_scc1 E_SPIN
E_VP:
    v_and_b32 v2, 63, v0
    v_lshlrev_b32 v2, 7, v2
    s_mov_b32 s76, 8585216
    buffer_load_dwordx2 v[4:5], v2, s[32:35], s76 offen sc1
    s_sub_u32 s75, s75, 1
    s_cmp_eq_u32 s75, 0
    s_waitcnt vmcnt(0)
    s_cbranch_scc1 E_VC
    v_cmp_ne_u32 vcc, v4, v125
    s_cbranch_vccnz E_VP
E_VC:
    v_cmp_eq_u32 vcc, 1, v5
    s_bcnt1_i32_b64 s76, vcc
    s_cmp_ge_u32 s76, 32
    s_cselect_b32 s76, 3, 2
    v_mov_b32 v2, 108864
    v_mov_b32 v3, s76
    ds_write_b32 v2, v3
    s_movk_i32 s28, 0x7fff
E_SPIN:
    v_mov_b32 v7, 108864
    ds_read_b32 v7, v7
    s_waitcnt lgkmcnt(0)
    v_readfirstlane_b32 s80, v7
    s_cmp_eq_u32 s80, 0
    s_cbranch_scc1 E_SPIN
    s_branch E_HAVEC
A_OVER:
    s_add_u32 s36, s18, 41943040
    s_addc_u32 s37, s19, 0
    s_mov_b32 s38, 8388608
    s_mov_b32 s39, s23
    s_lshl_b32 s62, s2, 15
    s_mov_b64 exec, s[52:53]
    s_cbranch_execz A_OV0
    ds_add_rtn_u32 v3, v6, v1 offset:34816
    v_mov_b32 v4, v16
    v_mov_b32 v5, v12
    s_waitcnt lgkmcnt(0)
    v_cmp_le_u32 s[76:77], 7, v3
    v_cmp_gt_u32 vcc, 14, v3
    v_lshlrev_b32 v2, 4, v3
    v_add_u32 v7, -104, v2
    v_cndmask_b32 v2, v2, v7, s[76:77]
    v_lshlrev_b32 v3, 3, v3
    s_andn2_b64 s[76:77], exec, vcc
    s_mov_b64 exec, vcc
    ds_write_b64 v2, v[4:5] offset:37888
    s_mov_b64 exec, s[76:77]
    s_cbranch_execz A_OV0
    buffer_store_dwordx2 v[4:5], v3, s[36:39], s62 offen sc1
    s_waitcnt vmcnt(0)
A_OV0:
    s_mov_b64 exec, s[54:55]
    s_cbranch_execz A_OV1
    ds_add_rtn_u32 v3, v6, v1 offset:34816
    v_mov_b32 v4, v17
    v_mov_b32 v5, v13
    s_waitcnt lgkmcnt(0)
    v_cmp_le_u32 s[76:77], 7, v3
    v_cmp_gt_u32 vcc, 14, v3
    v_lshlrev_b32 v2, 4, v3
    v_add_u32 v7, -104, v2
    v_cndmask_b32 v2, v2, v7, s[76:77]
    v_lshlrev_b32 v3, 3, v3
    s_andn2_b64 s[76:77], exec, vcc
    s_mov_b64 exec, vcc
    ds_write_b64 v2, v[4:5] offset:37888
    s_mov_b64 exec, s[76:77]
    s_cbranch_execz A_OV1
    buffer_store_dwordx2 v[4:5], v3, s[36:39], s62 offen sc1
    s_waitcnt vmcnt(0)
A_OV1:
    s_mov_b64 exec, s[56:57]
    s_cbranch_execz A_OV2
    ds_add_rtn_u32 v3, v6, v1 offset:34816
    v_mov_b32 v4, v18
    v_mov_b32 v5, v14
    s_waitcnt lgkmcnt(0)
    v_cmp_le_u32 s[76:77], 7, v3
    v_cmp_gt_u32 vcc, 14, v3
    v_lshlrev_b32 v2, 4, v3
    v_add_u32 v7, -104, v2
    v_cndmask_b32 v2, v2, v7, s[76:77]
    v_lshlrev_b32 v3, 3, v3
    s_andn2_b64 s[76:77], exec, vcc
    s_mov_b64 exec, vcc
    ds_write_b64 v2, v[4:5] offset:37888
    s_mov_b64 exec, s[76:77]
    s_cbranch_execz A_OV2
    buffer_store_dwordx2 v[4:5], v3, s[36:39], s62 offen sc1
    s_waitcnt vmcnt(0)
A_OV2:
    s_mov_b64 exec, s[58:59]
    s_cbranch_execz A_OV3
    ds_add_rtn_u32 v3, v6, v1 offset:34816
    v_mov_b32 v4, v19
    v_mov_b32 v5, v15
    s_waitcnt lgkmcnt(0)
    v_cmp_le_u32 s[76:77], 7, v3
    v_cmp_gt_u32 vcc, 14, v3
    v_lshlrev_b32 v2, 4, v3
    v_add_u32 v7, -104, v2
    v_cndmask_b32 v2, v2, v7, s[76:77]
    v_lshlrev_b32 v3, 3, v3
    s_andn2_b64 s[76:77], exec, vcc
    s_mov_b64 exec, vcc
    ds_write_b64 v2, v[4:5] offset:37888
    s_mov_b64 exec, s[76:77]
    s_cbranch_execz A_OV3
    buffer_store_dwordx2 v[4:5], v3, s[36:39], s62 offen sc1
    s_waitcnt vmcnt(0)
A_OV3:
    s_branch A_OUT
AGAIN:
    s_setprio 0
    s_or_b32 s71, s71, 2
    s_barrier
    v_lshlrev_b32 v2, 2, v0
    v_add_u32 v2, 106752, v2
    v_mov_b32 v3, 0
    v_cmp_gt_u32 vcc, 528, v0
    s_and_saveexec_b64 s[76:77], vcc
    ds_write_b32 v2, v3
    s_mov_b64 exec, -1
    s_waitcnt lgkmcnt(0)
    s_barrier
    s_mov_b64 exec, s[52:53]
    ds_add_rtn_u32 v32, v40, v1
    s_mov_b64 exec, s[54:55]
    ds_add_rtn_u32 v33, v41, v1
    s_mov_b64 exec, s[56:57]
    ds_add_rtn_u32 v34, v42, v1
    s_mov_b64 exec, s[58:59]
    ds_add_rtn_u32 v35, v43, v1
    s_mov_b64 exec, s[60:61]
    ds_add_rtn_u32 v36, v44, v1
    s_mov_b64 exec, s[62:63]
    ds_add_rtn_u32 v37, v45, v1
    s_mov_b64 exec, s[64:65]
    ds_add_rtn_u32 v38, v46, v1
    s_mov_b64 exec, -1
    v_lshrrev_b32 v93, 3, v0
    v_lshlrev_b32 v93, 7, v93
    v_lshl_add_u32 v93, v10, 4, v93
    buffer_load_dwordx4 v[20:23], v93, s[32:35], s30 offen sc1
    buffer_load_dwordx4 v[24:27], v93, s[32:35], s31 offen sc1
    s_waitcnt vmcnt(0)
    v_and_b32 v21, 0xffff, v21
    v_and_b32 v23, 0xffff, v23
    v_and_b32 v25, 0xffff, v25
    v_and_b32 v27, 0xffff, v27
    s_branch EXTRA
EXTRA0:
    s_cmp_eq_u64 s[72:73], 0
    s_cbranch_scc1 EXTRA
    v_and_b32 v23, 0xffff, v23
    v_and_b32 v27, 0xffff, v27
    v_mul_u32_u24 v2, 5368, v23
    v_mul_u32_u24 v3, 5368, v27
    v_lshrrev_b32 v2, 20, v2
    v_lshrrev_b32 v3, 20, v3
    v_cmp_eq_u32 s[82:83], s2, v2
    v_cmp_eq_u32 s[84:85], s2, v3
EXTRA:
    s_andn2_b64 exec, s[4:5], s[66:67]
    s_cbranch_execz X7_0
    s_andn2_b64 s[4:5], s[4:5], exec
    s_or_b64 s[66:67], s[66:67], exec
    v_mul_u32_u24 v30, 5368, v21
    v_lshrrev_b32 v30, 12, v30
    v_bfi_b32 v30, 15, v21, v30
    v_add_u32 v2, s27, v20
    v_and_b32_sdwa v3, v30, v99 dst_sel:DWORD dst_unused:UNUSED_PAD src0_sel:BYTE_0 src1_sel:DWORD
    v_bfe_u32 v2, v2, 12, 4
    v_or_b32 v2, v2, v3
    v_lshl_add_u32 v47, v2, 2, s0
    v_lshlrev_b32_sdwa v55, v124, v20 dst_sel:DWORD dst_unused:UNUSED_PAD src0_sel:DWORD src1_sel:WORD_0
    v_mov_b32 v63, v20
    v_lshlrev_b16_sdwa v63, v30, v1 dst_sel:WORD_0 dst_unused:UNUSED_PRESERVE src0_sel:BYTE_0 src1_sel:DWORD
X7_0:
    s_andn2_b64 exec, s[6:7], s[66:67]
    s_cbranch_execz X7_1
    s_andn2_b64 s[6:7], s[6:7], exec
    s_or_b64 s[66:67], s[66:67], exec
    v_mul_u32_u24 v30, 5368, v25
    v_lshrrev_b32 v30, 12, v30
    v_bfi_b32 v30, 15, v25, v30
    v_add_u32 v2, s27, v24
    v_and_b32_sdwa v3, v30, v99 dst_sel:DWORD dst_unused:UNUSED_PAD src0_sel:BYTE_0 src1_sel:DWORD
    v_bfe_u32 v2, v2, 12, 4
    v_or_b32 v2, v2, v3
    v_lshl_add_u32 v47, v2, 2, s0
    v_lshlrev_b32_sdwa v55, v124, v24 dst_sel:DWORD dst_unused:UNUSED_PAD src0_sel:DWORD src1_sel:WORD_0
    v_mov_b32 v63, v24
    v_lshlrev_b16_sdwa v63, v30, v1 dst_sel:WORD_0 dst_unused:UNUSED_PRESERVE src0_sel:BYTE_0 src1_sel:DWORD
X7_1:
    s_andn2_b64 exec, s[82:83], s[66:67]
    s_cbranch_execz X7_2
    s_andn2_b64 s[82:83], s[82:83], exec
    s_or_b64 s[66:67], s[66:67], exec
    v_mul_u32_u24 v30, 5368, v23
    v_lshrrev_b32 v30, 12, v30
    v_bfi_b32 v30, 15, v23, v30
    v_add_u32 v2, s27, v22
    v_and_b32_sdwa v3, v30, v99 dst_sel:DWORD dst_unused:UNUSED_PAD src0_sel:BYTE_0 src1_sel:DWORD
    v_bfe_u32 v2, v2, 12, 4
    v_or_b32 v2, v2, v3
    v_lshl_add_u32 v47, v2, 2, s0
    v_lshlrev_b32_sdwa v55, v124, v22 dst_sel:DWORD dst_unused:UNUSED_PAD src0_sel:DWORD src1_sel:WORD_0
    v_mov_b32 v63, v22
    v_lshlrev_b16_sdwa v63, v30, v1 dst_sel:WORD_0 dst_unused:UNUSED_PRESERVE src0_sel:BYTE_0 src1_sel:DWORD
X7_2:
    s_andn2_b64 exec, s[84:85], s[66:67]
    s_cbranch_execz X7_3
    s_andn2_b64 s[84:85], s[84:85], exec
    s_or_b64 s[66:67], s[66:67], exec
    v_mul_u32_u24 v30, 5368, v27
    v_lshrrev_b32 v30, 12, v30
    v_bfi_b32 v30, 15, v27, v30
    v_add_u32 v2, s27, v26
    v_and_b32_sdwa v3, v30, v99 dst_sel:DWORD dst_unused:UNUSED_PAD src0_sel:BYTE_0 src1_sel:DWORD
    v_bfe_u32 v2, v2, 12, 4
    v_or_b32 v2, v2, v3
    v_lshl_add_u32 v47, v2, 2, s0
    v_lshlrev_b32_sdwa v55, v124, v26 dst_sel:DWORD dst_unused:UNUSED_PAD src0_sel:DWORD src1_sel:WORD_0
    v_mov_b32 v63, v26
    v_lshlrev_b16_sdwa v63, v30, v1 dst_sel:WORD_0 dst_unused:UNUSED_PRESERVE src0_sel:BYTE_0 src1_sel:DWORD
X7_3:
    s_andn2_b64 exec, s[4:5], s[64:65]
    s_andn2_b64 exec, exec, s[12:13]
    s_cbranch_execz X6_0
    s_andn2_b64 s[4:5], s[4:5], exec
    s_or_b64 s[64:65], s[64:65], exec
    v_mul_u32_u24 v30, 5368, v21
    v_lshrrev_b32 v30, 12, v30
    v_bfi_b32 v30, 15, v21, v30
    v_add_u32 v2, s27, v20
    v_and_b32_sdwa v3, v30, v99 dst_sel:DWORD dst_unused:UNUSED_PAD src0_sel:BYTE_0 src1_sel:DWORD
    v_bfe_u32 v2, v2, 12, 4
    v_or_b32 v2, v2, v3
    v_lshl_add_u32 v46, v2, 2, s0
    v_lshlrev_b32_sdwa v54, v124, v20 dst_sel:DWORD dst_unused:UNUSED_PAD src0_sel:DWORD src1_sel:WORD_0
    v_mov_b32 v62, v20
    v_lshlrev_b16_sdwa v62, v30, v1 dst_sel:WORD_0 dst_unused:UNUSED_PRESERVE src0_sel:BYTE_0 src1_sel:DWORD
    ds_add_rtn_u32 v38, v46, v1
X6_0:
    s_andn2_b64 exec, s[6:7], s[64:65]
    s_andn2_b64 exec, exec, s[12:13]
    s_cbranch_execz X6_1
    s_andn2_b64 s[6:7], s[6:7], exec
    s_or_b64 s[64:65], s[64:65], exec
    v_mul_u32_u24 v30, 5368, v25
    v_lshrrev_b32 v30, 12, v30
    v_bfi_b32 v30, 15, v25, v30
    v_add_u32 v2, s27, v24
    v_and_b32_sdwa v3, v30, v99 dst_sel:DWORD dst_unused:UNUSED_PAD src0_sel:BYTE_0 src1_sel:DWORD
    v_bfe_u32 v2, v2, 12, 4
    v_or_b32 v2, v2, v3
    v_lshl_add_u32 v46, v2, 2, s0
    v_lshlrev_b32_sdwa v54, v124, v24 dst_sel:DWORD dst_unused:UNUSED_PAD src0_sel:DWORD src1_sel:WORD_0
    v_mov_b32 v62, v24
    v_lshlrev_b16_sdwa v62, v30, v1 dst_sel:WORD_0 dst_unused:UNUSED_PRESERVE src0_sel:BYTE_0 src1_sel:DWORD
    ds_add_rtn_u32 v38, v46, v1
X6_1:
    s_andn2_b64 exec, s[82:83], s[64:65]
    s_andn2_b64 exec, exec, s[12:13]
    s_cbranch_execz X6_2
    s_andn2_b64 s[82:83], s[82:83], exec
    s_or_b64 s[64:65], s[64:65], exec
    v_mul_u32_u24 v30, 5368, v23
    v_lshrrev_b32 v30, 12, v30
    v_bfi_b32 v30, 15, v23, v30
    v_add_u32 v2, s27, v22
    v_and_b32_sdwa v3, v30, v99 dst_sel:DWORD dst_unused:UNUSED_PAD src0_sel:BYTE_0 src1_sel:DWORD
    v_bfe_u32 v2, v2, 12, 4
    v_or_b32 v2, v2, v3
    v_lshl_add_u32 v46, v2, 2, s0
    v_lshlrev_b32_sdwa v54, v124, v22 dst_sel:DWORD dst_unused:UNUSED_PAD src0_sel:DWORD src1_sel:WORD_0
    v_mov_b32 v62, v22
    v_lshlrev_b16_sdwa v62, v30, v1 dst_sel:WORD_0 dst_unused:UNUSED_PRESERVE src0_sel:BYTE_0 src1_sel:DWORD
    ds_add_rtn_u32 v38, v46, v1
X6_2:
    s_andn2_b64 exec, s[84:85], s[64:65]
    s_andn2_b64 exec, exec, s[12:13]
    s_cbranch_execz X6_3
    s_andn2_b64 s[84:85], s[84:85], exec
    s_or_b64 s[64:65], s[64:65], exec
    v_mul_u32_u24 v30, 5368, v27
    v_lshrrev_b32 v30, 12, v30
    v_bfi_b32 v30, 15, v27, v30
    v_add_u32 v2, s27, v26
    v_and_b32_sdwa v3, v30, v99 dst_sel:DWORD dst_unused:UNUSED_PAD src0_sel:BYTE_0 src1_sel:DWORD
    v_bfe_u32 v2, v2, 12, 4
    v_or_b32 v2, v2, v3
    v_lshl_add_u32 v46, v2, 2, s0
    v_lshlrev_b32_sdwa v54, v124, v26 dst_sel:DWORD dst_unused:UNUSED_PAD src0_sel:DWORD src1_sel:WORD_0
    v_mov_b32 v62, v26
    v_lshlrev_b16_sdwa v62, v30, v1 dst_sel:WORD_0 dst_unused:UNUSED_PRESERVE src0_sel:BYTE_0 src1_sel:DWORD
    ds_add_rtn_u32 v38, v46, v1
X6_3:
    s_mov_b64 exec, -1
    s_or_b64 s[76:77], s[4:5], s[6:7]
    s_or_b64 s[76:77], s[76:77], s[82:83]
    s_or_b64 s[76:77], s[76:77], s[84:85]
    s_cbranch_scc1 OVFULL
    s_mov_b32 s75, 0
OVL:
    s_cmp_lt_u32 s68, s69
    s_cbranch_scc1 OVLOAD
    s_cmp_eq_u64 s[72:73], 0
    s_cbranch_scc1 OVDONE
    s_ff1_i32_b64 s76, s[72:73]
    s_bitset0_b64 s[72:73], s76
    s_or_b32 s77, s76, 7
    v_readlane_b32 s68, v21, s77
    v_readlane_b32 s69, v25, s77
    s_sub_u32 s75, 63, s77
    s_bitcmp1_b32 s76, 0
    s_cselect_b32 s69, s69, s68
    s_and_b32 s69, s69, 0xfff
    s_min_u32 s69, s69, 3328
    s_and_b32 s77, s76, 1
    s_lshl_b32 s77, s77, 7
    s_lshr_b32 s76, s76, 3
    s_add_u32 s76, s76, s77
    s_lshl_b32 s77, s3, 3
    s_add_u32 s76, s76, s77
    s_lshl_b32 s70, s76, 15
    s_mov_b32 s68, 14
    s_branch OVL
OVLOAD:
    v_add_u32 v4, s75, v0
    v_and_b32 v4, 63, v4
    v_add_u32 v4, s68, v4
    v_lshlrev_b32 v5, 3, v4
    buffer_load_dwordx2 v[28:29], v5, s[36:39], s70 offen sc1
    s_waitcnt vmcnt(0)
    v_mul_u32_u24 v30, 5368, v29
    v_lshrrev_b32 v31, 20, v30
    v_cmp_gt_u32 vcc, s69, v4
    v_cmp_eq_u32 s[76:77], s2, v31
    s_and_b64 vcc, s[76:77], vcc
    s_and_b64 s[76:77], vcc, s[66:67]
    s_cbranch_scc1 OVFULL
    s_or_b64 s[66:67], s[66:67], vcc
    s_add_u32 s68, s68, 64
    s_mov_b64 exec, vcc
    v_mul_u32_u24 v30, 5368, v29
    v_lshrrev_b32 v30, 12, v30
    v_bfi_b32 v30, 15, v29, v30
    v_add_u32 v2, s27, v28
    v_and_b32_sdwa v3, v30, v99 dst_sel:DWORD dst_unused:UNUSED_PAD src0_sel:BYTE_0 src1_sel:DWORD
    v_bfe_u32 v2, v2, 12, 4
    v_or_b32 v2, v2, v3
    v_lshl_add_u32 v47, v2, 2, s0
    v_lshlrev_b32_sdwa v55, v124, v28 dst_sel:DWORD dst_unused:UNUSED_PAD src0_sel:DWORD src1_sel:WORD_0
    v_mov_b32 v63, v28
    v_lshlrev_b16_sdwa v63, v30, v1 dst_sel:WORD_0 dst_unused:UNUSED_PRESERVE src0_sel:BYTE_0 src1_sel:DWORD
    s_mov_b64 exec, -1
    s_branch OVL
OVFULL:
    v_mov_b32 v2, 108800
    ds_write_b32 v2, v1
OVDONE:
    s_mov_b64 exec, s[66:67]
    ds_add_rtn_u32 v39, v47, v1
    s_mov_b64 exec, -1
    s_branch CDONE
SLOWW:
    s_waitcnt lgkmcnt(0)
    s_mov_b64 exec, s[52:53]
    v_lshl_add_u32 v20, v32, 2, v20
    v_subrev_u32 v3, s0, v40
    v_lshrrev_b32 v3, 6, v3
    v_mul_u32_u24 v3, 2560, v3
    v_add_u32 v3, 66816, v3
    v_cmp_lt_u32 vcc, v20, v3
    s_andn2_b64 s[52:53], exec, vcc
    s_mov_b64 exec, vcc
    ds_write2st64_b32 v20, v48, v56 offset0:0 offset1:5
    s_mov_b64 exec, s[54:55]
    v_lshl_add_u32 v21, v33, 2, v21
    v_subrev_u32 v3, s0, v41
    v_lshrrev_b32 v3, 6, v3
    v_mul_u32_u24 v3, 2560, v3
    v_add_u32 v3, 66816, v3
    v_cmp_lt_u32 vcc, v21, v3
    s_andn2_b64 s[54:55], exec, vcc
    s_mov_b64 exec, vcc
    ds_write2st64_b32 v21, v49, v57 offset0:0 offset1:5
    s_mov_b64 exec, s[56:57]
    v_lshl_add_u32 v22, v34, 2, v22
    v_subrev_u32 v3, s0, v42
    v_lshrrev_b32 v3, 6, v3
    v_mul_u32_u24 v3, 2560, v3
    v_add_u32 v3, 66816, v3
    v_cmp_lt_u32 vcc, v22, v3
    s_andn2_b64 s[56:57], exec, vcc
    s_mov_b64 exec, vcc
    ds_write2st64_b32 v22, v50, v58 offset0:0 offset1:5
    s_mov_b64 exec, s[58:59]
    v_lshl_add_u32 v23, v35, 2, v23
    v_subrev_u32 v3, s0, v43
    v_lshrrev_b32 v3, 6, v3
    v_mul_u32_u24 v3, 2560, v3
    v_add_u32 v3, 66816, v3
    v_cmp_lt_u32 vcc, v23, v3
    s_andn2_b64 s[58:59], exec, vcc
    s_mov_b64 exec, vcc
    ds_write2st64_b32 v23, v51, v59 offset0:0 offset1:5
    s_mov_b64 exec, s[60:61]
    v_lshl_add_u32 v24, v36, 2, v24
    v_subrev_u32 v3, s0, v44
    v_lshrrev_b32 v3, 6, v3
    v_mul_u32_u24 v3, 2560, v3
    v_add_u32 v3, 66816, v3
    v_cmp_lt_u32 vcc, v24, v3
    s_andn2_b64 s[60:61], exec, vcc
    s_mov_b64 exec, vcc
    ds_write2st64_b32 v24, v52, v60 offset0:0 offset1:5
    s_mov_b64 exec, s[62:63]
    v_lshl_add_u32 v25, v37, 2, v25
    v_subrev_u32 v3, s0, v45
    v_lshrrev_b32 v3, 6, v3
    v_mul_u32_u24 v3, 2560, v3
    v_add_u32 v3, 66816, v3
    v_cmp_lt_u32 vcc, v25, v3
    s_andn2_b64 s[62:63], exec, vcc
    s_mov_b64 exec, vcc
    ds_write2st64_b32 v25, v53, v61 offset0:0 offset1:5
    s_mov_b64 exec, s[64:65]
    v_lshl_add_u32 v26, v38, 2, v26
    v_subrev_u32 v3, s0, v46
    v_lshrrev_b32 v3, 6, v3
    v_mul_u32_u24 v3, 2560, v3
    v_add_u32 v3, 66816, v3
    v_cmp_lt_u32 vcc, v26, v3
    s_andn2_b64 s[64:65], exec, vcc
    s_mov_b64 exec, vcc
    ds_write2st64_b32 v26, v54, v62 offset0:0 offset1:5
    s_mov_b64 exec, s[66:67]
    v_lshl_add_u32 v27, v39, 2, v27
    v_subrev_u32 v3, s0, v47
    v_lshrrev_b32 v3, 6, v3
    v_mul_u32_u24 v3, 2560, v3
    v_add_u32 v3, 66816, v3
    v_cmp_lt_u32 vcc, v27, v3
    s_andn2_b64 s[66:67], exec, vcc
    s_mov_b64 exec, vcc
    ds_write2st64_b32 v27, v55, v63 offset0:0 offset1:5
    s_mov_b64 exec, -1
    v_mov_b32 v3, 108800
    ds_write_b32 v3, v1
    s_branch WDONE
REMAP2:
    ds_read_b32 v32, v123 offset:0
    ds_read_b32 v33, v123 offset:256
    ds_read_b32 v34, v123 offset:512
    ds_read_b32 v35, v123 offset:768
    ds_read_b32 v36, v123 offset:1024
    v_mov_b32 v37, 5368
    v_mov_b32 v38, 0x2000
    s_lshl_b32 s76, s81, 20
    s_waitcnt lgkmcnt(4)
    v_lshrrev_b32 v2, 7, v32
    v_lshrrev_b32 v39, 1, v32
    v_mad_u32_u24 v3, v2, v37, s76
    v_lshrrev_b32 v3, 7, v3
    v_bitop3_b32 v3, v32, v39, v3 bitop3:0xa8
    v_and_b32 v39, 0xffffe000, v32
    v_bitop3_b32 v3, v3, v2, s80 bitop3:0x96
    v_add_u32 v32, v32, v39
    v_and_or_b32 v32, v3, v38, v32
    ds_write_b32 v123, v32 offset:0
    s_waitcnt lgkmcnt(4)
    v_lshrrev_b32 v2, 7, v33
    v_lshrrev_b32 v39, 1, v33
    v_mad_u32_u24 v3, v2, v37, s76
    v_lshrrev_b32 v3, 7, v3
    v_bitop3_b32 v3, v33, v39, v3 bitop3:0xa8
    v_and_b32 v39, 0xffffe000, v33
    v_bitop3_b32 v3, v3, v2, s80 bitop3:0x96
    v_add_u32 v33, v33, v39
    v_and_or_b32 v33, v3, v38, v33
    ds_write_b32 v123, v33 offset:256
    s_waitcnt lgkmcnt(4)
    v_lshrrev_b32 v2, 7, v34
    v_lshrrev_b32 v39, 1, v34
    v_mad_u32_u24 v3, v2, v37, s76
    v_lshrrev_b32 v3, 7, v3
    v_bitop3_b32 v3, v34, v39, v3 bitop3:0xa8
    v_and_b32 v39, 0xffffe000, v34
    v_bitop3_b32 v3, v3, v2, s80 bitop3:0x96
    v_add_u32 v34, v34, v39
    v_and_or_b32 v34, v3, v38, v34
    ds_write_b32 v123, v34 offset:512
    s_cmpk_le_u32 s74, 192
    s_cbranch_scc1 RW2
    s_waitcnt lgkmcnt(4)
    v_lshrrev_b32 v2, 7, v35
    v_lshrrev_b32 v39, 1, v35
    v_mad_u32_u24 v3, v2, v37, s76
    v_lshrrev_b32 v3, 7, v3
    v_bitop3_b32 v3, v35, v39, v3 bitop3:0xa8
    v_and_b32 v39, 0xffffe000, v35
    v_bitop3_b32 v3, v3, v2, s80 bitop3:0x96
    v_add_u32 v35, v35, v39
    v_and_or_b32 v35, v3, v38, v35
    ds_write_b32 v123, v35 offset:768
    s_cmpk_le_u32 s74, 256
    s_cbranch_scc1 RW2
    s_waitcnt lgkmcnt(4)
    v_lshrrev_b32 v2, 7, v36
    v_lshrrev_b32 v39, 1, v36
    v_mad_u32_u24 v3, v2, v37, s76
    v_lshrrev_b32 v3, 7, v3
    v_bitop3_b32 v3, v36, v39, v3 bitop3:0xa8
    v_and_b32 v39, 0xffffe000, v36
    v_bitop3_b32 v3, v3, v2, s80 bitop3:0x96
    v_add_u32 v36, v36, v39
    v_and_or_b32 v36, v3, v38, v36
    ds_write_b32 v123, v36 offset:1024
RW2:
    s_branch MAIN1
E_IRR:
    s_mov_b32 s70, s77
    v_lshlrev_b32 v2, 2, v0
    v_add_u32 v2, 106752, v2
    v_mov_b32 v3, 0
    v_cmp_gt_u32 vcc, 256, v0
    s_and_saveexec_b64 s[76:77], vcc
    ds_write_b32 v2, v3
    s_mov_b64 exec, -1
    s_mov_b32 s77, s70
    v_lshrrev_b32 v9, 3, v0
    v_lshlrev_b32 v93, 7, v9
    v_lshlrev_b32 v9, 15, v9
    v_lshl_add_u32 v9, v10, 4, v9
    v_lshl_add_u32 v93, v10, 4, v93
    v_mov_b32 v100, 1073741824
    v_mov_b32 v101, 1073741824
    v_mov_b32 v102, 1073741824
    v_mov_b32 v103, 1073741824
    s_waitcnt lgkmcnt(0)
    s_branch E_BAR
EMPTY:
    s_waitcnt vmcnt(0) lgkmcnt(0)
    s_bitcmp1_b32 s71, 3
    s_cbranch_scc1 MAINDONE
    s_or_b32 s71, s71, 8
    v_bfe_u32 v2, v121, 13, 2
    v_and_b32 v9, 0xffffe000, v121
    v_cmp_gt_u32 s[78:79], 1, v2
    v_add_u32 v9, v9, v121
    v_lshrrev_b32 v2, 8, v9
    v_and_b32 v2, 0x2000, v2
    v_xor_b32 v9, v9, v2
    s_and_b32 s76, s26, 3
    s_or_b32 s76, s76, s3
    s_cbranch_scc1 PRB_E
    s_or_b32 s71, s71, 0
    s_branch PROBE
PRB_E:
    s_mov_b64 exec, s[16:17]
    v_swap_b32 v64, v66
    v_swap_b32 v65, v67
    v_swap_b32 v68, v70
    v_swap_b32 v69, v71
    s_mov_b64 exec, -1
    v_and_b32 v79, 0xffff0000, v71
    v_lshlrev_b32 v78, 16, v71
    v_and_b32 v77, 0xffff0000, v70
    v_lshlrev_b32 v76, 16, v70
    v_and_b32 v75, 0xffff0000, v69
    v_lshlrev_b32 v74, 16, v69
    v_and_b32 v73, 0xffff0000, v68
    v_lshlrev_b32 v72, 16, v68
    v_and_b32 v71, 0xffff0000, v67
    v_lshlrev_b32 v70, 16, v67
    v_and_b32 v69, 0xffff0000, v66
    v_lshlrev_b32 v68, 16, v66
    v_and_b32 v67, 0xffff0000, v65
    v_lshlrev_b32 v66, 16, v65
    v_and_b32 v65, 0xffff0000, v64
    v_lshlrev_b32 v64, 16, v64
    v_mul_f32 v64, v126, v64
    v_mul_f32 v65, v126, v65
    v_mul_f32 v66, v126, v66
    v_mul_f32 v67, v126, v67
    v_mul_f32 v68, v126, v68
    v_mul_f32 v69, v126, v69
    v_mul_f32 v70, v126, v70
    v_mul_f32 v71, v126, v71
    v_mul_f32 v72, v126, v72
    v_mul_f32 v73, v126, v73
    v_mul_f32 v74, v126, v74
    v_mul_f32 v75, v126, v75
    v_mul_f32 v76, v126, v76
    v_mul_f32 v77, v126, v77
    v_mul_f32 v78, v126, v78
    v_mul_f32 v79, v126, v79
    s_branch MAINDONE
F_GETW:
    s_waitcnt lgkmcnt(0)
    v_xor_b32 v5, 8, v122
    v_xor_b32 v6, 64, v122
    v_xor_b32 v7, 72, v122
    ds_read_b64_tr_b16 v[40:41], v122 offset:0
    ds_read_b64_tr_b16 v[42:43], v122 offset:512
    ds_read_b64_tr_b16 v[44:45], v5 offset:0
    ds_read_b64_tr_b16 v[46:47], v5 offset:512
    ds_read_b64_tr_b16 v[48:49], v6 offset:0
    ds_read_b64_tr_b16 v[50:51], v6 offset:512
    ds_read_b64_tr_b16 v[52:53], v7 offset:0
    ds_read_b64_tr_b16 v[54:55], v7 offset:512
    ds_read_b64_tr_b16 v[56:57], v122 offset:4096
    ds_read_b64_tr_b16 v[58:59], v122 offset:4608
    ds_read_b64_tr_b16 v[60:61], v5 offset:4096
    ds_read_b64_tr_b16 v[62:63], v5 offset:4608
    ds_read_b64_tr_b16 v[28:29], v6 offset:4096
    ds_read_b64_tr_b16 v[30:31], v6 offset:4608
    ds_read_b64_tr_b16 v[96:97], v7 offset:4096
    ds_read_b64_tr_b16 v[98:99], v7 offset:4608
    s_waitcnt lgkmcnt(0)
    s_branch F_HAVEW
CODE_END:
.section .rodata,"a"
.p2align 6
.amdhsa_kernel standalone__spectral_conv_sgc__graph_kernel
  .amdhsa_next_free_vgpr 128
  .amdhsa_next_free_sgpr 86
  .amdhsa_accum_offset 128
  .amdhsa_group_segment_fixed_size 0
  .amdhsa_kernarg_size 64
  .amdhsa_user_sgpr_count 2
  .amdhsa_user_sgpr_kernarg_segment_ptr 1
  .amdhsa_system_sgpr_workgroup_id_x 1
.end_amdhsa_kernel
```
